```python
import torch

def _softmax(x, axis=-1):
    return torch.softmax(x, dim=axis)
def _gelu(x):
    return torch.nn.functional.gelu(x, approximate="tanh")
def _silu(x):
    return torch.nn.functional.silu(x)
def _sigmoid(x):
    return torch.sigmoid(x)
def _layernorm(x, axis=-1, eps=1e-5):
    m = x.mean(dim=axis, keepdim=True)
    v = x.var(dim=axis, keepdim=True, unbiased=False)
    return (x - m) / torch.sqrt(v + eps)
def _scatter_add(tgt, idx, src, axis=0):
    return tgt.clone().index_add_(axis, idx, src)
def _segment_sum(src, seg, n):
    out = torch.zeros((n,) + src.shape[1:], dtype=src.dtype)
    return out.index_add_(0, seg, src)
def _pad(x, pw):
    flat = tuple(v for pair in reversed(pw) for v in pair)
    return torch.nn.functional.pad(x, flat)

kernel_name = 'standalone__self_sup_conv_stem_wavlm__speech'

def setup_inputs():

    _w = (lambda a: (lambda t: t.to(torch.bfloat16) if t.is_floating_point() else t)(torch.as_tensor(a)))
    B, T, D, K = 2, 16000, 256, 31
    scale = (K * D) ** -0.5
    return {
        "x": _w((lambda *s: torch.randn(*s, dtype=torch.bfloat16) * 0.05)(B, T, D)),
        "w": _w((lambda *s: torch.randn(*s, dtype=torch.bfloat16) * 0.05)(K, D, D) * scale),
        "gn_gamma": _w((lambda *s: torch.randn(*s, dtype=torch.bfloat16) * 0.05)(D) * 0.1 + 1.0),
        "gn_beta": _w((lambda *s: torch.randn(*s, dtype=torch.bfloat16) * 0.05)(D) * 0.1),
    }

def reference(x, w, gn_gamma, gn_beta):
    B, T, D = x.shape
    K = w.shape[0]
    s = 2
    L = (T - K) // s + 1
    h = torch.einsum('blc,cd->bld', x[:, 0:s * L:s, :], w[0])
    for i in range(1, K):
        h = h + torch.einsum('blc,cd->bld', x[:, i:i + s * L:s, :], w[i])
    mu = torch.einsum('bld->bd', h)[:, None, :] / L
    var = torch.einsum('bld->bd', (h - mu) ** 2)[:, None, :] / L
    h = (h - mu) / torch.sqrt(var + 1e-5)
    h = h * gn_gamma[None, None, :] + gn_beta[None, None, :]
    return _gelu(h)
```

```asm
; @launch grid=(256,1,1) block=(256,1,1) lds=136448
.amdgcn_target "amdgcn-amd-amdhsa--gfx950"
.text
.globl standalone__self_sup_conv_stem_wavlm__speech_kernel
.p2align 8
.type standalone__self_sup_conv_stem_wavlm__speech_kernel,@function
standalone__self_sup_conv_stem_wavlm__speech_kernel:
s_cmp_ge_u32 s2, 256
s_cbranch_scc1 LM_done
s_load_dwordx8 s[4:11], s[0:1], 0
s_load_dwordx4 s[12:15], s[0:1], 32
s_load_dwordx2 s[16:17], s[0:1], 48
s_memrealtime s[40:41]
v_mov_b32 v232, v0
s_getpc_b64 s[62:63]
LM_pc:
s_lshr_b32 s61, s2, 3
s_lshl_b32 s61, s61, 10
v_and_b32 v5, 7, v0
v_lshlrev_b32 v5, 7, v5
v_add_u32 v5, s61, v5
v_min_u32 v5, LM_done-LM_pc, v5
v_mov_b32 v251, s63
v_add_co_u32 v250, vcc, s62, v5
s_mov_b64 exec, 0xff
v_addc_co_u32 v251, vcc, 0, v251, vcc
s_mov_b64 exec, -1
v_lshrrev_b32 v1, 6, v0
v_and_b32 v2, 63, v0
v_readfirstlane_b32 s44, v1
s_lshr_b32 s46, s2, 6
s_and_b32 s56, s2, 7
s_bfe_u32 s57, s2, 0x30003
s_lshl_b32 s56, s56, 3
s_add_u32 s80, s56, s57
s_lshr_b32 s47, s80, 5
s_and_b32 s45, s80, 31
s_mul_i32 s48, s45, 255
v_and_b32 v3, 15, v2
v_lshrrev_b32 v4, 4, v2
v_lshrrev_b32 v5, 2, v2
v_lshlrev_b32 v6, 1, v5
v_subrev_u32 v7, 15, v6
v_cmp_gt_u32 vcc, 8, v5
v_and_b32 v8, 3, v2
v_lshlrev_b32 v213, 4, v2
v_cndmask_b32 v6, v7, v6, vcc
v_lshlrev_b32 v6, 10, v6
v_lshl_add_u32 v208, v8, 4, v6
v_add_u32 v209, 65536, v208
v_add_u32 v210, 131072, v208
v_add_u32 v211, 196608, v208
v_xor_b32 v209, 32, v209
v_xor_b32 v211, 32, v211
v_lshl_add_u32 v5, v1, 2, v4
v_lshlrev_b32 v6, 1, v5
v_subrev_u32 v7, 15, v6
v_cmp_gt_u32 vcc, 8, v5
v_sub_u32 v9, 16, v1
s_mul_i32 s53, s44, 1600
v_cndmask_b32 v6, v7, v6, vcc
v_lshlrev_b32 v6, 10, v6
v_lshl_add_u32 v6, v3, 2, v6
v_lshl_add_u32 v212, v9, 14, v6
s_lshl_b32 s55, s44, 8
s_add_u32 s55, s55, 25600
s_lshl_b32 s49, s48, 10
s_lshl_b32 s58, s44, 14
s_add_u32 s49, s49, s58
s_add_u32 s50, s49, 512
s_mul_i32 s56, s47, 8192000
v_lshrrev_b32 v5, 3, v2
v_bfe_u32 v6, v2, 4, 1
v_and_b32 v7, 1, v1
v_lshl_or_b32 v6, v7, 1, v6
v_lshlrev_b32 v6, 1, v6
v_and_b32 v7, 7, v2
v_xor_b32 v6, v6, v7
v_lshlrev_b32 v6, 4, v6
v_lshl_add_u32 v5, v1, 3, v5
v_lshl_add_u32 v237, v5, 9, v6
s_lshl_b32 s85, s44, 10
s_add_u32 s85, s85, 54528
s_lshl_b32 s84, s46, 7
s_waitcnt lgkmcnt(0)
s_add_u32 s20, s4, s56
s_addc_u32 s21, s5, 0
s_mov_b32 s22, 8191488
s_mov_b32 s23, 0x00020000
s_add_u32 m0, s53, 0
s_nop 0
buffer_load_dwordx4 v208, s[20:23], s49 offen lds
s_add_u32 m0, s53, 6400
s_nop 0
buffer_load_dwordx4 v209, s[20:23], s49 offen lds
s_add_u32 m0, s53, 12800
s_nop 0
buffer_load_dwordx4 v210, s[20:23], s49 offen lds
s_add_u32 m0, s53, 19200
s_nop 0
buffer_load_dwordx4 v211, s[20:23], s49 offen lds
s_add_u32 m0, s55, 0
s_nop 0
buffer_load_dword v212, s[20:23], s49 offen lds
s_mov_b32 s64, s6
s_mov_b32 s65, s7
s_mov_b32 s66, 4063232
s_mov_b32 s67, 0x00020000
s_add_u32 m0, s85, 0
s_add_u32 s86, s84, 0
buffer_load_dwordx4 v237, s[64:67], s86 offen lds
s_add_u32 m0, s85, 4096
s_add_u32 s86, s84, 524288
buffer_load_dwordx4 v237, s[64:67], s86 offen lds
s_add_u32 m0, s85, 8192
s_add_u32 s86, s84, 1048576
buffer_load_dwordx4 v237, s[64:67], s86 offen lds
s_add_u32 m0, s85, 12288
s_add_u32 s86, s84, 1572864
buffer_load_dwordx4 v237, s[64:67], s86 offen lds
s_add_u32 m0, s85, 16384
s_add_u32 s86, s84, 2097152
buffer_load_dwordx4 v237, s[64:67], s86 offen lds
s_add_u32 m0, s85, 20480
s_add_u32 s86, s84, 2621440
buffer_load_dwordx4 v237, s[64:67], s86 offen lds
s_add_u32 m0, s85, 24576
s_add_u32 s86, s84, 3145728
buffer_load_dwordx4 v237, s[64:67], s86 offen lds
s_add_u32 m0, s85, 28672
s_add_u32 s86, s84, 3670016
buffer_load_dwordx4 v237, s[64:67], s86 offen lds
s_mov_b64 exec, 0xff
global_load_dword v239, v[250:251], off
s_mov_b64 exec, -1
s_lshr_b32 s72, s80, 3
s_bfe_u32 s73, s80, 0x10002
s_and_b32 s74, s80, 3
s_lshl_b32 s75, s74, 3
s_add_u32 s75, s75, s73
s_lshl_b32 s75, s75, 17
s_lshl_b32 s76, s72, 14
s_add_u32 s75, s75, s76
s_add_u32 s75, s75, s84
s_mul_i32 s79, s72, 48
s_mul_i32 s73, s73, 24
s_add_u32 s79, s79, s73
s_lshl_b32 s74, s74, 1
s_add_u32 s79, s79, s74
s_lshl_b32 s79, s79, 10
s_lshl_b32 s57, s46, 2
s_add_u32 s57, s57, s44
s_mul_i32 s58, s57, 393216
s_lshl_b32 s59, s47, 4
s_add_u32 s59, s59, s57
s_lshl_b32 s59, s59, 12
s_add_u32 s59, s59, 6815744
s_add_u32 s24, s16, s58
s_addc_u32 s25, s17, 0
s_mov_b32 s26, 393216
s_mov_b32 s27, 0x00020000
s_add_u32 s32, s16, s59
s_addc_u32 s33, s17, 0
s_mov_b32 s34, 4096
s_mov_b32 s35, 0x00020000
s_mov_b32 s68, s14
s_mov_b32 s69, s15
s_mov_b32 s70, 256
s_mov_b32 s71, 0x00020000
s_add_u32 s36, s16, 7077888
s_addc_u32 s37, s17, 0
s_mov_b32 s38, 32768
s_mov_b32 s39, 0x00020000
s_movk_i32 s56, 1600
v_mul_lo_u32 v204, v3, s56
v_lshl_add_u32 v204, v4, 4, v204
v_add_u32 v224, 1600, v204
v_and_b32 v7, 4, v3
v_lshlrev_b32 v7, 3, v7
v_xor_b32 v204, v204, v7
v_add_u32 v7, 1, v3
v_and_b32 v7, 4, v7
v_lshlrev_b32 v7, 3, v7
v_xor_b32 v224, v224, v7
v_lshrrev_b32 v7, 5, v2
v_lshl_add_u32 v7, v1, 2, v7
v_mul_lo_u32 v7, v7, s56
v_bfe_u32 v9, v2, 2, 3
v_lshl_add_u32 v7, v9, 6, v7
v_lshl_add_u32 v205, v8, 4, v7
v_cmp_eq_u32 vcc, 7, v9
v_add_u32 v7, 64, v205
v_add_u32 v10, 1152, v205
v_cndmask_b32 v206, v7, v10, vcc
v_cmp_lt_u32 vcc, 59, v2
v_xor_b32 v7, 32, v206
s_nop 0
v_cndmask_b32 v225, v206, v7, vcc
v_and_b32 v7, 1, v4
v_lshl_add_u32 v7, v1, 1, v7
v_lshlrev_b32 v7, 6, v7
v_lshl_add_u32 v7, v3, 2, v7
v_add_u32 v207, 25600, v7
s_mov_b32 s54, 0xffff0000
v_lshrrev_b32 v7, 2, v3
v_lshl_add_u32 v7, v4, 3, v7
v_lshlrev_b32 v7, 7, v7
v_lshrrev_b32 v9, 3, v3
v_and_b32 v10, 1, v4
v_lshl_or_b32 v9, v10, 1, v9
v_xor_b32 v9, v9, v1
v_lshl_add_u32 v7, v9, 5, v7
v_lshl_add_u32 v7, v8, 3, v7
v_add_u32 v238, 54528, v7
v_add_u32 v218, 120064, v7
s_lshl_b32 s87, s46, 6
s_add_u32 s88, s87, s80
s_lshl_b32 s88, s88, 7
s_lshl_b32 s87, s87, 7
s_cmp_eq_u32 s44, 0
s_cselect_b32 s88, s88, 0x10000
s_cselect_b32 s89, 0, 0x10000
s_or_b32 s61, s40, 1
s_or_b32 s62, s41, 0x80000000
v_mov_b32 v192, s61
v_mov_b32 v193, s62
s_or_b32 s61, s2, s44
s_cselect_b32 s61, 0x10000, 0
v_lshlrev_b32 v219, 7, v2
v_mov_b32 v220, 0
s_lshr_b32 s76, s2, 3
s_lshl_b32 s76, s76, 17
v_lshlrev_b32 v221, 7, v232
s_mov_b64 exec, 1
buffer_store_dwordx2 v[192:193], v220, s[68:71], s61 offen sc1
s_mov_b64 exec, -1
s_mov_b32 s90, 0
s_mov_b32 s52, 0
s_mov_b32 s51, 73728
v_and_b32 v222, 31, v2
v_lshlrev_b32 v222, 2, v222
v_mov_b32 v223, -1
s_lshl_b32 s60, s45, 7
s_cmp_lt_u32 s80, 12
s_cselect_b32 s79, 0x7f000000, s79
s_add_u32 s73, s79, 8192
s_add_u32 s74, s79, 16384
v_mov_b32 v0, 0
v_mov_b32 v1, 0
v_mov_b32 v2, 0
v_mov_b32 v3, 0
v_mov_b32 v4, 0
v_mov_b32 v5, 0
v_mov_b32 v6, 0
v_mov_b32 v7, 0
v_mov_b32 v8, 0
v_mov_b32 v9, 0
v_mov_b32 v10, 0
v_mov_b32 v11, 0
v_mov_b32 v12, 0
v_mov_b32 v13, 0
v_mov_b32 v14, 0
v_mov_b32 v15, 0
v_mov_b32 v16, 0
v_mov_b32 v17, 0
v_mov_b32 v18, 0
v_mov_b32 v19, 0
v_mov_b32 v20, 0
v_mov_b32 v21, 0
v_mov_b32 v22, 0
v_mov_b32 v23, 0
v_mov_b32 v24, 0
v_mov_b32 v25, 0
v_mov_b32 v26, 0
v_mov_b32 v27, 0
v_mov_b32 v28, 0
v_mov_b32 v29, 0
v_mov_b32 v30, 0
v_mov_b32 v31, 0
v_mov_b32 v32, 0
v_mov_b32 v33, 0
v_mov_b32 v34, 0
v_mov_b32 v35, 0
v_mov_b32 v36, 0
v_mov_b32 v37, 0
v_mov_b32 v38, 0
v_mov_b32 v39, 0
v_mov_b32 v40, 0
v_mov_b32 v41, 0
v_mov_b32 v42, 0
v_mov_b32 v43, 0
v_mov_b32 v44, 0
v_mov_b32 v45, 0
v_mov_b32 v46, 0
v_mov_b32 v47, 0
v_mov_b32 v48, 0
v_mov_b32 v49, 0
v_mov_b32 v50, 0
v_mov_b32 v51, 0
v_mov_b32 v52, 0
v_mov_b32 v53, 0
v_mov_b32 v54, 0
v_mov_b32 v55, 0
v_mov_b32 v56, 0
v_mov_b32 v57, 0
v_mov_b32 v58, 0
v_mov_b32 v59, 0
v_mov_b32 v60, 0
v_mov_b32 v61, 0
v_mov_b32 v62, 0
v_mov_b32 v63, 0
v_mov_b32 v64, 0
v_mov_b32 v65, 0
v_mov_b32 v66, 0
v_mov_b32 v67, 0
v_mov_b32 v68, 0
v_mov_b32 v69, 0
v_mov_b32 v70, 0
v_mov_b32 v71, 0
v_mov_b32 v72, 0
v_mov_b32 v73, 0
v_mov_b32 v74, 0
v_mov_b32 v75, 0
v_mov_b32 v76, 0
v_mov_b32 v77, 0
v_mov_b32 v78, 0
v_mov_b32 v79, 0
v_mov_b32 v80, 0
v_mov_b32 v81, 0
v_mov_b32 v82, 0
v_mov_b32 v83, 0
v_mov_b32 v84, 0
v_mov_b32 v85, 0
v_mov_b32 v86, 0
v_mov_b32 v87, 0
v_mov_b32 v88, 0
v_mov_b32 v89, 0
v_mov_b32 v90, 0
v_mov_b32 v91, 0
v_mov_b32 v92, 0
v_mov_b32 v93, 0
v_mov_b32 v94, 0
v_mov_b32 v95, 0
s_add_u32 m0, s85, 32768
s_add_u32 s86, s84, 262144
buffer_load_dwordx4 v237, s[64:67], s86 offen lds
s_add_u32 m0, s85, 36864
s_add_u32 s86, s84, 786432
buffer_load_dwordx4 v237, s[64:67], s86 offen lds
s_add_u32 m0, s85, 40960
s_add_u32 s86, s84, 1310720
buffer_load_dwordx4 v237, s[64:67], s86 offen lds
s_add_u32 m0, s85, 45056
s_add_u32 s86, s84, 1835008
buffer_load_dwordx4 v237, s[64:67], s86 offen lds
s_add_u32 m0, s85, 49152
s_add_u32 s86, s84, 2359296
buffer_load_dwordx4 v237, s[64:67], s86 offen lds
s_add_u32 m0, s85, 53248
s_add_u32 s86, s84, 2883584
buffer_load_dwordx4 v237, s[64:67], s86 offen lds
s_add_u32 m0, s85, 57344
s_add_u32 s86, s84, 3407872
buffer_load_dwordx4 v237, s[64:67], s86 offen lds
s_add_u32 m0, s85, 61440
s_add_u32 s86, s84, 3932160
buffer_load_dwordx4 v237, s[64:67], s86 offen lds
s_add_u32 s84, s84, 131072
s_waitcnt vmcnt(10)
s_barrier
ds_read_b64_tr_b16 v[96:97], v238 offset:0
ds_read_b64_tr_b16 v[98:99], v238 offset:512
ds_read_b64_tr_b16 v[100:101], v238 offset:4096
ds_read_b64_tr_b16 v[102:103], v238 offset:4608
ds_read_b64_tr_b16 v[104:105], v238 offset:8192
ds_read_b64_tr_b16 v[106:107], v238 offset:8704
ds_read_b64_tr_b16 v[108:109], v238 offset:12288
ds_read_b64_tr_b16 v[110:111], v238 offset:12800
ds_read_b64_tr_b16 v[112:113], v238 offset:16384
ds_read_b64_tr_b16 v[114:115], v238 offset:16896
ds_read_b64_tr_b16 v[116:117], v238 offset:20480
ds_read_b64_tr_b16 v[118:119], v238 offset:20992
ds_read_b64_tr_b16 v[120:121], v238 offset:24576
ds_read_b64_tr_b16 v[122:123], v238 offset:25088
ds_read_b64_tr_b16 v[124:125], v238 offset:28672
ds_read_b64_tr_b16 v[126:127], v238 offset:29184
ds_read_b128 a[0:3], v204 offset:0
ds_read_b128 a[4:7], v204 offset:64
ds_read_b128 a[8:11], v204 offset:128
ds_read_b128 a[12:15], v204 offset:192
ds_read_b128 a[16:19], v204 offset:256
ds_read_b128 a[20:23], v204 offset:320
ds_read_b128 a[24:27], v204 offset:384
ds_read_b128 a[28:31], v204 offset:448
ds_read_b128 a[32:35], v224 offset:0
ds_read_b128 a[36:39], v224 offset:64
ds_read_b128 a[40:43], v224 offset:128
ds_read_b128 a[44:47], v224 offset:192
ds_read_b128 a[48:51], v224 offset:256
ds_read_b128 a[52:55], v224 offset:320
ds_read_b128 a[56:59], v224 offset:384
s_add_u32 m0, s53, 27200
s_nop 0
buffer_load_dwordx4 v208, s[20:23], s50 offen lds
s_add_u32 m0, s53, 33600
s_nop 0
buffer_load_dwordx4 v209, s[20:23], s50 offen lds
s_add_u32 m0, s53, 40000
s_nop 0
buffer_load_dwordx4 v210, s[20:23], s50 offen lds
s_add_u32 m0, s53, 46400
s_nop 0
buffer_load_dwordx4 v211, s[20:23], s50 offen lds
s_add_u32 m0, s55, 27200
s_nop 0
buffer_load_dword v212, s[20:23], s50 offen lds
s_mov_b32 s91, 0x10000
buffer_load_dwordx2 v[216:217], v219, s[36:39], s91 offen sc1
s_cmp_eq_u32 s44, 0
s_cselect_b32 s91, s87, 0x10000
s_add_u32 s49, s49, 64
s_add_u32 s50, s50, 64
s_waitcnt lgkmcnt(0)
s_barrier
.p2align 6
LM_u0:
v_mfma_f32_16x16x32_bf16 v[0:3], v[96:99], a[0:3], v[0:3]
ds_read_b128 v[192:195], v205 offset:512
ds_read_b128 v[196:199], v206 offset:0
v_mfma_f32_16x16x32_bf16 v[0:3], v[100:103], a[4:7], v[0:3]
ds_read_b32 v230, v207 offset:512
v_mfma_f32_16x16x32_bf16 v[4:7], v[96:99], a[4:7], v[4:7]
ds_read_b128 a[60:63], v204 offset:512
ds_read_b32 v231, v207 offset:64
v_mfma_f32_16x16x32_bf16 v[4:7], v[100:103], a[8:11], v[4:7]
v_mfma_f32_16x16x32_bf16 v[8:11], v[96:99], a[8:11], v[8:11]
v_mfma_f32_16x16x32_bf16 v[8:11], v[100:103], a[12:15], v[8:11]
ds_read_b128 a[64:67], v204 offset:576
v_mfma_f32_16x16x32_bf16 v[12:15], v[96:99], a[12:15], v[12:15]
v_mfma_f32_16x16x32_bf16 v[12:15], v[100:103], a[16:19], v[12:15]
v_mfma_f32_16x16x32_bf16 v[16:19], v[96:99], a[16:19], v[16:19]
ds_read_b128 a[68:71], v204 offset:640
s_waitcnt lgkmcnt(5)
v_lshlrev_b32 v200, 16, v192
v_lshlrev_b32 v201, 16, v196
v_and_b32 v202, s54, v192
v_and_b32 v203, s54, v196
v_sub_f32 v200, v200, v201
v_sub_f32 v202, v202, v203
v_cvt_pk_bf16_f32 v192, v200, v202
v_lshlrev_b32 v200, 16, v193
v_mfma_f32_16x16x32_bf16 v[16:19], v[100:103], a[20:23], v[16:19]
v_lshlrev_b32 v201, 16, v197
v_mfma_f32_16x16x32_bf16 v[20:23], v[96:99], a[20:23], v[20:23]
v_and_b32 v202, s54, v193
v_and_b32 v203, s54, v197
v_mfma_f32_16x16x32_bf16 v[20:23], v[100:103], a[24:27], v[20:23]
v_sub_f32 v200, v200, v201
v_mfma_f32_16x16x32_bf16 v[24:27], v[96:99], a[24:27], v[24:27]
ds_read_b128 a[72:75], v204 offset:704
v_sub_f32 v202, v202, v203
v_cvt_pk_bf16_f32 v193, v200, v202
v_mfma_f32_16x16x32_bf16 v[24:27], v[100:103], a[28:31], v[24:27]
v_lshlrev_b32 v200, 16, v194
v_mfma_f32_16x16x32_bf16 v[28:31], v[96:99], a[28:31], v[28:31]
v_lshlrev_b32 v201, 16, v198
v_mfma_f32_16x16x32_bf16 v[28:31], v[100:103], a[32:35], v[28:31]
ds_read_b128 a[76:79], v204 offset:768
v_and_b32 v202, s54, v194
v_and_b32 v203, s54, v198
v_mfma_f32_16x16x32_bf16 v[0:3], v[104:107], a[8:11], v[0:3]
v_sub_f32 v200, v200, v201
v_mfma_f32_16x16x32_bf16 v[0:3], v[108:111], a[12:15], v[0:3]
v_sub_f32 v202, v202, v203
v_mfma_f32_16x16x32_bf16 v[4:7], v[104:107], a[12:15], v[4:7]
ds_read_b128 a[80:83], v204 offset:832
v_cvt_pk_bf16_f32 v194, v200, v202
v_lshlrev_b32 v200, 16, v195
v_mfma_f32_16x16x32_bf16 v[4:7], v[108:111], a[16:19], v[4:7]
v_lshlrev_b32 v201, 16, v199
v_mfma_f32_16x16x32_bf16 v[8:11], v[104:107], a[16:19], v[8:11]
v_and_b32 v202, s54, v195
v_and_b32 v203, s54, v199
v_mfma_f32_16x16x32_bf16 v[8:11], v[108:111], a[20:23], v[8:11]
v_sub_f32 v200, v200, v201
v_mfma_f32_16x16x32_bf16 v[12:15], v[104:107], a[20:23], v[12:15]
ds_read_b128 a[84:87], v204 offset:896
v_sub_f32 v202, v202, v203
v_mfma_f32_16x16x32_bf16 v[12:15], v[108:111], a[24:27], v[12:15]
v_cvt_pk_bf16_f32 v195, v200, v202
ds_write_b128 v205, v[192:195] offset:1024
v_mfma_f32_16x16x32_bf16 v[16:19], v[104:107], a[24:27], v[16:19]
s_waitcnt lgkmcnt(7)
v_mfma_f32_16x16x32_bf16 v[16:19], v[108:111], a[28:31], v[16:19]
ds_read_b128 a[88:91], v204 offset:960
v_lshlrev_b32 v200, 16, v230
v_lshlrev_b32 v201, 16, v231
v_mfma_f32_16x16x32_bf16 v[20:23], v[104:107], a[28:31], v[20:23]
v_and_b32 v202, s54, v230
v_mfma_f32_16x16x32_bf16 v[20:23], v[108:111], a[32:35], v[20:23]
v_and_b32 v203, s54, v231
v_mfma_f32_16x16x32_bf16 v[24:27], v[104:107], a[32:35], v[24:27]
s_waitcnt vmcnt(6)
s_barrier
ds_read_b128 a[92:95], v224 offset:512
v_sub_f32 v200, v200, v201
v_sub_f32 v202, v202, v203
v_mfma_f32_16x16x32_bf16 v[24:27], v[108:111], a[36:39], v[24:27]
v_cvt_pk_bf16_f32 v230, v200, v202
v_mfma_f32_16x16x32_bf16 v[28:31], v[104:107], a[36:39], v[28:31]
ds_read_b64_tr_b16 v[128:129], v238 offset:32768
ds_write_b32 v207, v230 offset:1024
ds_read_b128 v[192:195], v205 offset:3712
v_mfma_f32_16x16x32_bf16 v[28:31], v[108:111], a[40:43], v[28:31]
s_add_u32 m0, s85, 65536
s_add_u32 s86, s75, 0
ds_read_b64_tr_b16 v[130:131], v238 offset:33280
ds_read_b128 v[196:199], v225 offset:3200
v_mfma_f32_16x16x32_bf16 v[0:3], v[112:115], a[16:19], v[0:3]
buffer_load_dwordx4 v237, s[64:67], s86 offen lds
v_mfma_f32_16x16x32_bf16 v[0:3], v[116:119], a[20:23], v[0:3]
s_add_u32 m0, s85, 69632
ds_read_b64_tr_b16 v[132:133], v238 offset:36864
ds_read_b128 a[96:99], v224 offset:576
v_mfma_f32_16x16x32_bf16 v[4:7], v[112:115], a[20:23], v[4:7]
s_add_u32 s86, s75, 262144
ds_read_b64_tr_b16 v[134:135], v238 offset:37376
v_mfma_f32_16x16x32_bf16 v[4:7], v[116:119], a[24:27], v[4:7]
buffer_load_dwordx4 v237, s[64:67], s86 offen lds
v_mfma_f32_16x16x32_bf16 v[8:11], v[112:115], a[24:27], v[8:11]
s_add_u32 m0, s85, 73728
s_add_u32 s86, s75, 524288
ds_read_b64_tr_b16 v[136:137], v238 offset:40960
ds_read_b128 a[100:103], v224 offset:640
v_mfma_f32_16x16x32_bf16 v[8:11], v[116:119], a[28:31], v[8:11]
buffer_load_dwordx4 v237, s[64:67], s86 offen lds
v_mfma_f32_16x16x32_bf16 v[12:15], v[112:115], a[28:31], v[12:15]
s_add_u32 m0, s85, 77824
ds_read_b64_tr_b16 v[138:139], v238 offset:41472
ds_read_b128 a[104:107], v224 offset:704
s_waitcnt lgkmcnt(7)
v_lshlrev_b32 v200, 16, v192
v_lshlrev_b32 v201, 16, v196
v_and_b32 v202, s54, v192
v_and_b32 v203, s54, v196
v_sub_f32 v200, v200, v201
v_sub_f32 v202, v202, v203
v_cvt_pk_bf16_f32 v192, v200, v202
v_lshlrev_b32 v200, 16, v193
v_lshlrev_b32 v201, 16, v197
v_mfma_f32_16x16x32_bf16 v[12:15], v[116:119], a[32:35], v[12:15]
s_add_u32 s86, s75, 786432
ds_read_b64_tr_b16 v[140:141], v238 offset:45056
v_and_b32 v202, s54, v193
v_mfma_f32_16x16x32_bf16 v[16:19], v[112:115], a[32:35], v[16:19]
buffer_load_dwordx4 v237, s[64:67], s86 offen lds
v_mfma_f32_16x16x32_bf16 v[16:19], v[116:119], a[36:39], v[16:19]
s_add_u32 m0, s85, 0
s_add_u32 s86, s84, 0
ds_read_b64_tr_b16 v[142:143], v238 offset:45568
v_and_b32 v203, s54, v197
v_sub_f32 v200, v200, v201
v_sub_f32 v202, v202, v203
v_mfma_f32_16x16x32_bf16 v[20:23], v[112:115], a[36:39], v[20:23]
buffer_load_dwordx4 v237, s[64:67], s86 offen lds
v_mfma_f32_16x16x32_bf16 v[20:23], v[116:119], a[40:43], v[20:23]
s_add_u32 m0, s85, 4096
ds_read_b64_tr_b16 v[144:145], v238 offset:49152
ds_read_b64_tr_b16 v[146:147], v238 offset:49664
ds_read_b128 a[108:111], v224 offset:768
v_cvt_pk_bf16_f32 v193, v200, v202
v_lshlrev_b32 v200, 16, v194
v_lshlrev_b32 v201, 16, v198
v_mfma_f32_16x16x32_bf16 v[24:27], v[112:115], a[40:43], v[24:27]
s_add_u32 s86, s84, 524288
v_and_b32 v202, s54, v194
v_mfma_f32_16x16x32_bf16 v[24:27], v[116:119], a[44:47], v[24:27]
buffer_load_dwordx4 v237, s[64:67], s86 offen lds
v_mfma_f32_16x16x32_bf16 v[28:31], v[112:115], a[44:47], v[28:31]
s_add_u32 m0, s85, 8192
s_add_u32 s86, s84, 1048576
ds_read_b64_tr_b16 v[148:149], v238 offset:53248
ds_read_b64_tr_b16 v[150:151], v238 offset:53760
ds_read_b128 a[112:115], v224 offset:832
v_and_b32 v203, s54, v198
v_sub_f32 v200, v200, v201
v_sub_f32 v202, v202, v203
v_mfma_f32_16x16x32_bf16 v[28:31], v[116:119], a[48:51], v[28:31]
buffer_load_dwordx4 v237, s[64:67], s86 offen lds
v_mfma_f32_16x16x32_bf16 v[0:3], v[120:123], a[24:27], v[0:3]
s_add_u32 m0, s85, 12288
ds_read_b64_tr_b16 v[152:153], v238 offset:57344
ds_read_b128 a[116:119], v224 offset:896
v_cvt_pk_bf16_f32 v194, v200, v202
v_lshlrev_b32 v200, 16, v195
v_lshlrev_b32 v201, 16, v199
v_mfma_f32_16x16x32_bf16 v[0:3], v[124:127], a[28:31], v[0:3]
s_add_u32 s86, s84, 1572864
ds_read_b64_tr_b16 v[154:155], v238 offset:57856
v_and_b32 v202, s54, v195
v_mfma_f32_16x16x32_bf16 v[4:7], v[120:123], a[28:31], v[4:7]
buffer_load_dwordx4 v237, s[64:67], s86 offen lds
v_mfma_f32_16x16x32_bf16 v[4:7], v[124:127], a[32:35], v[4:7]
s_add_u32 m0, s85, 16384
s_add_u32 s86, s84, 2097152
ds_read_b64_tr_b16 v[156:157], v238 offset:61440
v_and_b32 v203, s54, v199
v_sub_f32 v200, v200, v201
v_sub_f32 v202, v202, v203
v_mfma_f32_16x16x32_bf16 v[8:11], v[120:123], a[32:35], v[8:11]
buffer_load_dwordx4 v237, s[64:67], s86 offen lds
v_mfma_f32_16x16x32_bf16 v[8:11], v[124:127], a[36:39], v[8:11]
s_add_u32 m0, s85, 20480
ds_read_b64_tr_b16 v[158:159], v238 offset:61952
v_cvt_pk_bf16_f32 v195, v200, v202
ds_write_b128 v205, v[192:195] offset:4224
v_mfma_f32_16x16x32_bf16 v[12:15], v[120:123], a[36:39], v[12:15]
s_add_u32 s86, s84, 2621440
v_mfma_f32_16x16x32_bf16 v[12:15], v[124:127], a[40:43], v[12:15]
buffer_load_dwordx4 v237, s[64:67], s86 offen lds
v_mfma_f32_16x16x32_bf16 v[16:19], v[120:123], a[40:43], v[16:19]
s_add_u32 m0, s85, 24576
s_add_u32 s86, s84, 3145728
v_mfma_f32_16x16x32_bf16 v[16:19], v[124:127], a[44:47], v[16:19]
buffer_load_dwordx4 v237, s[64:67], s86 offen lds
v_mfma_f32_16x16x32_bf16 v[20:23], v[120:123], a[44:47], v[20:23]
s_add_u32 m0, s85, 28672
v_mfma_f32_16x16x32_bf16 v[20:23], v[124:127], a[48:51], v[20:23]
s_add_u32 s86, s84, 3670016
v_mfma_f32_16x16x32_bf16 v[24:27], v[120:123], a[48:51], v[24:27]
buffer_load_dwordx4 v237, s[64:67], s86 offen lds
v_mfma_f32_16x16x32_bf16 v[24:27], v[124:127], a[52:55], v[24:27]
v_mfma_f32_16x16x32_bf16 v[28:31], v[120:123], a[52:55], v[28:31]
v_mfma_f32_16x16x32_bf16 v[28:31], v[124:127], a[56:59], v[28:31]
s_waitcnt lgkmcnt(0)
s_waitcnt vmcnt(13)
s_barrier
v_mfma_f32_16x16x32_bf16 v[32:35], v[128:131], a[60:63], v[32:35]
s_add_u32 m0, s85, 32768
v_lshlrev_b32 v233, 16, v96
v_lshlrev_b32 v234, 16, v128
v_and_b32 v235, s54, v96
v_mfma_f32_16x16x32_bf16 v[32:35], v[132:135], a[64:67], v[32:35]
s_add_u32 s86, s84, 262144
v_and_b32 v236, s54, v128
v_sub_f32 v233, v233, v234
v_mfma_f32_16x16x32_bf16 v[36:39], v[128:131], a[64:67], v[36:39]
buffer_load_dwordx4 v237, s[64:67], s86 offen lds
v_mfma_f32_16x16x32_bf16 v[36:39], v[132:135], a[68:71], v[36:39]
s_add_u32 m0, s85, 36864
ds_read_b128 a[0:3], v204 offset:1024
v_sub_f32 v235, v235, v236
v_cvt_pk_bf16_f32 v160, v233, v235
v_lshlrev_b32 v233, 16, v97
v_lshlrev_b32 v234, 16, v129
v_mfma_f32_16x16x32_bf16 v[40:43], v[128:131], a[68:71], v[40:43]
s_add_u32 s86, s84, 786432
v_and_b32 v235, s54, v97
v_and_b32 v236, s54, v129
v_mfma_f32_16x16x32_bf16 v[40:43], v[132:135], a[72:75], v[40:43]
buffer_load_dwordx4 v237, s[64:67], s86 offen lds
v_mfma_f32_16x16x32_bf16 v[44:47], v[128:131], a[72:75], v[44:47]
s_add_u32 m0, s85, 40960
ds_read_b128 a[4:7], v204 offset:1088
v_sub_f32 v233, v233, v234
v_sub_f32 v235, v235, v236
v_cvt_pk_bf16_f32 v161, v233, v235
v_lshlrev_b32 v233, 16, v98
v_mfma_f32_16x16x32_bf16 v[44:47], v[132:135], a[76:79], v[44:47]
s_add_u32 s86, s84, 1310720
v_lshlrev_b32 v234, 16, v130
v_and_b32 v235, s54, v98
v_mfma_f32_16x16x32_bf16 v[48:51], v[128:131], a[76:79], v[48:51]
buffer_load_dwordx4 v237, s[64:67], s86 offen lds
v_mfma_f32_16x16x32_bf16 v[48:51], v[132:135], a[80:83], v[48:51]
s_add_u32 m0, s85, 45056
ds_read_b128 a[8:11], v204 offset:1152
v_and_b32 v236, s54, v130
v_sub_f32 v233, v233, v234
v_sub_f32 v235, v235, v236
v_cvt_pk_bf16_f32 v162, v233, v235
v_mfma_f32_16x16x32_bf16 v[52:55], v[128:131], a[80:83], v[52:55]
s_add_u32 s86, s84, 1835008
v_lshlrev_b32 v233, 16, v99
v_lshlrev_b32 v234, 16, v131
v_mfma_f32_16x16x32_bf16 v[52:55], v[132:135], a[84:87], v[52:55]
buffer_load_dwordx4 v237, s[64:67], s86 offen lds
v_mfma_f32_16x16x32_bf16 v[56:59], v[128:131], a[84:87], v[56:59]
s_add_u32 m0, s85, 49152
ds_read_b128 a[12:15], v204 offset:1216
v_and_b32 v235, s54, v99
v_and_b32 v236, s54, v131
v_sub_f32 v233, v233, v234
v_sub_f32 v235, v235, v236
v_mfma_f32_16x16x32_bf16 v[56:59], v[132:135], a[88:91], v[56:59]
s_add_u32 s86, s84, 2359296
v_cvt_pk_bf16_f32 v163, v233, v235
v_lshlrev_b32 v233, 16, v100
v_mfma_f32_16x16x32_bf16 v[60:63], v[128:131], a[88:91], v[60:63]
buffer_load_dwordx4 v237, s[64:67], s86 offen lds
v_mfma_f32_16x16x32_bf16 v[60:63], v[132:135], a[92:95], v[60:63]
s_add_u32 m0, s85, 53248
ds_read_b128 a[16:19], v204 offset:1280
v_lshlrev_b32 v234, 16, v132
v_and_b32 v235, s54, v100
v_and_b32 v236, s54, v132
v_sub_f32 v233, v233, v234
v_mfma_f32_16x16x32_bf16 v[32:35], v[136:139], a[68:71], v[32:35]
s_add_u32 s86, s84, 2883584
v_sub_f32 v235, v235, v236
v_cvt_pk_bf16_f32 v164, v233, v235
v_mfma_f32_16x16x32_bf16 v[32:35], v[140:143], a[72:75], v[32:35]
buffer_load_dwordx4 v237, s[64:67], s86 offen lds
v_mfma_f32_16x16x32_bf16 v[36:39], v[136:139], a[72:75], v[36:39]
s_add_u32 m0, s85, 57344
ds_read_b128 a[20:23], v204 offset:1344
v_lshlrev_b32 v233, 16, v101
v_lshlrev_b32 v234, 16, v133
v_and_b32 v235, s54, v101
v_and_b32 v236, s54, v133
v_mfma_f32_16x16x32_bf16 v[36:39], v[140:143], a[76:79], v[36:39]
s_add_u32 s86, s84, 3407872
v_sub_f32 v233, v233, v234
v_sub_f32 v235, v235, v236
v_mfma_f32_16x16x32_bf16 v[40:43], v[136:139], a[76:79], v[40:43]
buffer_load_dwordx4 v237, s[64:67], s86 offen lds
v_mfma_f32_16x16x32_bf16 v[40:43], v[140:143], a[80:83], v[40:43]
s_add_u32 m0, s85, 61440
v_cvt_pk_bf16_f32 v165, v233, v235
v_lshlrev_b32 v233, 16, v102
v_lshlrev_b32 v234, 16, v134
v_and_b32 v235, s54, v102
v_mfma_f32_16x16x32_bf16 v[44:47], v[136:139], a[80:83], v[44:47]
s_add_u32 s86, s84, 3932160
ds_read_b128 a[24:27], v204 offset:1408
v_and_b32 v236, s54, v134
v_sub_f32 v233, v233, v234
v_mfma_f32_16x16x32_bf16 v[44:47], v[140:143], a[84:87], v[44:47]
buffer_load_dwordx4 v237, s[64:67], s86 offen lds
v_mfma_f32_16x16x32_bf16 v[48:51], v[136:139], a[84:87], v[48:51]
s_add_u32 s84, s84, 4294852608
v_sub_f32 v235, v235, v236
v_cvt_pk_bf16_f32 v166, v233, v235
v_lshlrev_b32 v233, 16, v103
v_lshlrev_b32 v234, 16, v135
v_mfma_f32_16x16x32_bf16 v[48:51], v[140:143], a[88:91], v[48:51]
s_add_u32 m0, s53, 0
ds_read_b128 a[28:31], v204 offset:1472
v_and_b32 v235, s54, v103
v_and_b32 v236, s54, v135
v_mfma_f32_16x16x32_bf16 v[52:55], v[136:139], a[88:91], v[52:55]
buffer_load_dwordx4 v208, s[20:23], s49 offen lds
v_mfma_f32_16x16x32_bf16 v[52:55], v[140:143], a[92:95], v[52:55]
v_sub_f32 v233, v233, v234
v_sub_f32 v235, v235, v236
v_cvt_pk_bf16_f32 v167, v233, v235
v_lshlrev_b32 v233, 16, v104
v_mfma_f32_16x16x32_bf16 v[56:59], v[136:139], a[92:95], v[56:59]
s_add_u32 m0, s53, 6400
ds_read_b128 a[32:35], v224 offset:1024
v_lshlrev_b32 v234, 16, v136
v_and_b32 v235, s54, v104
v_mfma_f32_16x16x32_bf16 v[56:59], v[140:143], a[96:99], v[56:59]
buffer_load_dwordx4 v209, s[20:23], s49 offen lds
v_mfma_f32_16x16x32_bf16 v[60:63], v[136:139], a[96:99], v[60:63]
v_and_b32 v236, s54, v136
v_sub_f32 v233, v233, v234
v_sub_f32 v235, v235, v236
v_cvt_pk_bf16_f32 v168, v233, v235
v_mfma_f32_16x16x32_bf16 v[60:63], v[140:143], a[100:103], v[60:63]
s_add_u32 m0, s53, 12800
v_lshlrev_b32 v233, 16, v105
v_lshlrev_b32 v234, 16, v137
v_and_b32 v235, s54, v105
v_mfma_f32_16x16x32_bf16 v[32:35], v[144:147], a[76:79], v[32:35]
buffer_load_dwordx4 v210, s[20:23], s49 offen lds
v_mfma_f32_16x16x32_bf16 v[32:35], v[148:151], a[80:83], v[32:35]
ds_read_b128 a[36:39], v224 offset:1088
v_and_b32 v236, s54, v137
v_sub_f32 v233, v233, v234
v_sub_f32 v235, v235, v236
v_cvt_pk_bf16_f32 v169, v233, v235
v_mfma_f32_16x16x32_bf16 v[36:39], v[144:147], a[80:83], v[36:39]
s_add_u32 m0, s53, 19200
v_lshlrev_b32 v233, 16, v106
v_lshlrev_b32 v234, 16, v138
v_mfma_f32_16x16x32_bf16 v[36:39], v[148:151], a[84:87], v[36:39]
buffer_load_dwordx4 v211, s[20:23], s49 offen lds
v_mfma_f32_16x16x32_bf16 v[40:43], v[144:147], a[84:87], v[40:43]
ds_read_b128 a[40:43], v224 offset:1152
v_and_b32 v235, s54, v106
v_and_b32 v236, s54, v138
v_sub_f32 v233, v233, v234
v_sub_f32 v235, v235, v236
v_mfma_f32_16x16x32_bf16 v[40:43], v[148:151], a[88:91], v[40:43]
s_add_u32 m0, s55, 0
v_cvt_pk_bf16_f32 v170, v233, v235
v_lshlrev_b32 v233, 16, v107
v_mfma_f32_16x16x32_bf16 v[44:47], v[144:147], a[88:91], v[44:47]
buffer_load_dword v212, s[20:23], s49 offen lds
v_mfma_f32_16x16x32_bf16 v[44:47], v[148:151], a[92:95], v[44:47]
ds_read_b128 a[44:47], v224 offset:1216
v_lshlrev_b32 v234, 16, v139
v_and_b32 v235, s54, v107
v_and_b32 v236, s54, v139
v_sub_f32 v233, v233, v234
v_mfma_f32_16x16x32_bf16 v[48:51], v[144:147], a[92:95], v[48:51]
v_sub_f32 v235, v235, v236
v_cvt_pk_bf16_f32 v171, v233, v235
v_mfma_f32_16x16x32_bf16 v[48:51], v[148:151], a[96:99], v[48:51]
v_lshlrev_b32 v233, 16, v108
v_lshlrev_b32 v234, 16, v140
v_mfma_f32_16x16x32_bf16 v[52:55], v[144:147], a[96:99], v[52:55]
ds_read_b128 a[48:51], v224 offset:1280
v_and_b32 v235, s54, v108
v_and_b32 v236, s54, v140
v_mfma_f32_16x16x32_bf16 v[52:55], v[148:151], a[100:103], v[52:55]
v_sub_f32 v233, v233, v234
v_sub_f32 v235, v235, v236
v_mfma_f32_16x16x32_bf16 v[56:59], v[144:147], a[100:103], v[56:59]
v_cvt_pk_bf16_f32 v172, v233, v235
v_lshlrev_b32 v233, 16, v109
v_mfma_f32_16x16x32_bf16 v[56:59], v[148:151], a[104:107], v[56:59]
ds_read_b128 a[52:55], v224 offset:1344
v_lshlrev_b32 v234, 16, v141
v_and_b32 v235, s54, v109
v_mfma_f32_16x16x32_bf16 v[60:63], v[144:147], a[104:107], v[60:63]
v_and_b32 v236, s54, v141
v_sub_f32 v233, v233, v234
v_mfma_f32_16x16x32_bf16 v[60:63], v[148:151], a[108:111], v[60:63]
v_sub_f32 v235, v235, v236
v_cvt_pk_bf16_f32 v173, v233, v235
v_mfma_f32_16x16x32_bf16 v[32:35], v[152:155], a[84:87], v[32:35]
ds_read_b128 a[56:59], v224 offset:1408
v_lshlrev_b32 v233, 16, v110
v_lshlrev_b32 v234, 16, v142
v_mfma_f32_16x16x32_bf16 v[32:35], v[156:159], a[88:91], v[32:35]
v_and_b32 v235, s54, v110
v_and_b32 v236, s54, v142
v_mfma_f32_16x16x32_bf16 v[36:39], v[152:155], a[88:91], v[36:39]
v_sub_f32 v233, v233, v234
v_sub_f32 v235, v235, v236
v_mfma_f32_16x16x32_bf16 v[36:39], v[156:159], a[92:95], v[36:39]
v_cvt_pk_bf16_f32 v174, v233, v235
v_lshlrev_b32 v233, 16, v111
v_mfma_f32_16x16x32_bf16 v[40:43], v[152:155], a[92:95], v[40:43]
v_lshlrev_b32 v234, 16, v143
v_and_b32 v235, s54, v111
v_mfma_f32_16x16x32_bf16 v[40:43], v[156:159], a[96:99], v[40:43]
v_and_b32 v236, s54, v143
v_sub_f32 v233, v233, v234
v_mfma_f32_16x16x32_bf16 v[44:47], v[152:155], a[96:99], v[44:47]
v_sub_f32 v235, v235, v236
v_cvt_pk_bf16_f32 v175, v233, v235
v_mfma_f32_16x16x32_bf16 v[44:47], v[156:159], a[100:103], v[44:47]
v_lshlrev_b32 v233, 16, v112
v_lshlrev_b32 v234, 16, v144
v_mfma_f32_16x16x32_bf16 v[48:51], v[152:155], a[100:103], v[48:51]
v_and_b32 v235, s54, v112
v_and_b32 v236, s54, v144
v_mfma_f32_16x16x32_bf16 v[48:51], v[156:159], a[104:107], v[48:51]
v_sub_f32 v233, v233, v234
v_sub_f32 v235, v235, v236
v_mfma_f32_16x16x32_bf16 v[52:55], v[152:155], a[104:107], v[52:55]
v_cvt_pk_bf16_f32 v176, v233, v235
v_lshlrev_b32 v233, 16, v113
v_mfma_f32_16x16x32_bf16 v[52:55], v[156:159], a[108:111], v[52:55]
v_lshlrev_b32 v234, 16, v145
v_and_b32 v235, s54, v113
v_mfma_f32_16x16x32_bf16 v[56:59], v[152:155], a[108:111], v[56:59]
v_and_b32 v236, s54, v145
v_sub_f32 v233, v233, v234
v_mfma_f32_16x16x32_bf16 v[56:59], v[156:159], a[112:115], v[56:59]
v_sub_f32 v235, v235, v236
v_cvt_pk_bf16_f32 v177, v233, v235
v_mfma_f32_16x16x32_bf16 v[60:63], v[152:155], a[112:115], v[60:63]
v_mfma_f32_16x16x32_bf16 v[60:63], v[156:159], a[116:119], v[60:63]
s_waitcnt lgkmcnt(0)
v_mfma_f32_16x16x32_bf16 v[64:67], v[160:163], a[0:3], v[64:67]
v_lshlrev_b32 v233, 16, v114
v_lshlrev_b32 v234, 16, v146
v_and_b32 v235, s54, v114
v_mfma_f32_16x16x32_bf16 v[64:67], v[164:167], a[4:7], v[64:67]
v_and_b32 v236, s54, v146
v_sub_f32 v233, v233, v234
v_mfma_f32_16x16x32_bf16 v[68:71], v[160:163], a[4:7], v[68:71]
ds_read_b128 a[60:63], v204 offset:27200
v_sub_f32 v235, v235, v236
v_cvt_pk_bf16_f32 v178, v233, v235
v_mfma_f32_16x16x32_bf16 v[68:71], v[164:167], a[8:11], v[68:71]
v_lshlrev_b32 v233, 16, v115
v_lshlrev_b32 v234, 16, v147
v_and_b32 v235, s54, v115
v_mfma_f32_16x16x32_bf16 v[72:75], v[160:163], a[8:11], v[72:75]
v_and_b32 v236, s54, v147
v_sub_f32 v233, v233, v234
v_mfma_f32_16x16x32_bf16 v[72:75], v[164:167], a[12:15], v[72:75]
ds_read_b128 a[64:67], v204 offset:27264
v_sub_f32 v235, v235, v236
v_cvt_pk_bf16_f32 v179, v233, v235
v_mfma_f32_16x16x32_bf16 v[76:79], v[160:163], a[12:15], v[76:79]
v_lshlrev_b32 v233, 16, v116
v_lshlrev_b32 v234, 16, v148
v_and_b32 v235, s54, v116
v_mfma_f32_16x16x32_bf16 v[76:79], v[164:167], a[16:19], v[76:79]
v_and_b32 v236, s54, v148
v_sub_f32 v233, v233, v234
v_mfma_f32_16x16x32_bf16 v[80:83], v[160:163], a[16:19], v[80:83]
ds_read_b128 a[68:71], v204 offset:27328
v_sub_f32 v235, v235, v236
v_cvt_pk_bf16_f32 v180, v233, v235
v_mfma_f32_16x16x32_bf16 v[80:83], v[164:167], a[20:23], v[80:83]
v_lshlrev_b32 v233, 16, v117
v_lshlrev_b32 v234, 16, v149
v_and_b32 v235, s54, v117
v_mfma_f32_16x16x32_bf16 v[84:87], v[160:163], a[20:23], v[84:87]
v_and_b32 v236, s54, v149
v_sub_f32 v233, v233, v234
v_mfma_f32_16x16x32_bf16 v[84:87], v[164:167], a[24:27], v[84:87]
v_sub_f32 v235, v235, v236
v_cvt_pk_bf16_f32 v181, v233, v235
v_mfma_f32_16x16x32_bf16 v[88:91], v[160:163], a[24:27], v[88:91]
ds_read_b128 a[72:75], v204 offset:27392
v_lshlrev_b32 v233, 16, v118
v_lshlrev_b32 v234, 16, v150
v_and_b32 v235, s54, v118
v_mfma_f32_16x16x32_bf16 v[88:91], v[164:167], a[28:31], v[88:91]
v_and_b32 v236, s54, v150
v_sub_f32 v233, v233, v234
v_mfma_f32_16x16x32_bf16 v[92:95], v[160:163], a[28:31], v[92:95]
v_sub_f32 v235, v235, v236
v_cvt_pk_bf16_f32 v182, v233, v235
v_mfma_f32_16x16x32_bf16 v[92:95], v[164:167], a[32:35], v[92:95]
ds_read_b128 a[76:79], v204 offset:27456
v_lshlrev_b32 v233, 16, v119
v_lshlrev_b32 v234, 16, v151
v_and_b32 v235, s54, v119
v_mfma_f32_16x16x32_bf16 v[64:67], v[168:171], a[8:11], v[64:67]
v_and_b32 v236, s54, v151
v_sub_f32 v233, v233, v234
v_mfma_f32_16x16x32_bf16 v[64:67], v[172:175], a[12:15], v[64:67]
v_sub_f32 v235, v235, v236
v_cvt_pk_bf16_f32 v183, v233, v235
v_mfma_f32_16x16x32_bf16 v[68:71], v[168:171], a[12:15], v[68:71]
ds_read_b128 a[80:83], v204 offset:27520
v_lshlrev_b32 v233, 16, v120
v_lshlrev_b32 v234, 16, v152
v_and_b32 v235, s54, v120
v_mfma_f32_16x16x32_bf16 v[68:71], v[172:175], a[16:19], v[68:71]
v_and_b32 v236, s54, v152
v_sub_f32 v233, v233, v234
v_mfma_f32_16x16x32_bf16 v[72:75], v[168:171], a[16:19], v[72:75]
v_sub_f32 v235, v235, v236
v_cvt_pk_bf16_f32 v184, v233, v235
v_mfma_f32_16x16x32_bf16 v[72:75], v[172:175], a[20:23], v[72:75]
v_lshlrev_b32 v233, 16, v121
v_lshlrev_b32 v234, 16, v153
v_mfma_f32_16x16x32_bf16 v[76:79], v[168:171], a[20:23], v[76:79]
ds_read_b128 a[84:87], v204 offset:27584
v_and_b32 v235, s54, v121
v_and_b32 v236, s54, v153
v_mfma_f32_16x16x32_bf16 v[76:79], v[172:175], a[24:27], v[76:79]
v_sub_f32 v233, v233, v234
v_sub_f32 v235, v235, v236
v_mfma_f32_16x16x32_bf16 v[80:83], v[168:171], a[24:27], v[80:83]
v_cvt_pk_bf16_f32 v185, v233, v235
v_lshlrev_b32 v233, 16, v122
v_lshlrev_b32 v234, 16, v154
v_mfma_f32_16x16x32_bf16 v[80:83], v[172:175], a[28:31], v[80:83]
ds_read_b128 a[88:91], v204 offset:27648
v_and_b32 v235, s54, v122
v_and_b32 v236, s54, v154
v_mfma_f32_16x16x32_bf16 v[84:87], v[168:171], a[28:31], v[84:87]
v_sub_f32 v233, v233, v234
v_sub_f32 v235, v235, v236
v_mfma_f32_16x16x32_bf16 v[84:87], v[172:175], a[32:35], v[84:87]
v_cvt_pk_bf16_f32 v186, v233, v235
v_lshlrev_b32 v233, 16, v123
v_mfma_f32_16x16x32_bf16 v[88:91], v[168:171], a[32:35], v[88:91]
ds_read_b128 a[92:95], v224 offset:27200
v_lshlrev_b32 v234, 16, v155
v_and_b32 v235, s54, v123
v_mfma_f32_16x16x32_bf16 v[88:91], v[172:175], a[36:39], v[88:91]
v_and_b32 v236, s54, v155
v_sub_f32 v233, v233, v234
v_mfma_f32_16x16x32_bf16 v[92:95], v[168:171], a[36:39], v[92:95]
v_sub_f32 v235, v235, v236
v_cvt_pk_bf16_f32 v187, v233, v235
v_mfma_f32_16x16x32_bf16 v[92:95], v[172:175], a[40:43], v[92:95]
v_lshlrev_b32 v233, 16, v124
v_lshlrev_b32 v234, 16, v156
v_and_b32 v235, s54, v124
v_mfma_f32_16x16x32_bf16 v[64:67], v[176:179], a[16:19], v[64:67]
ds_read_b128 a[96:99], v224 offset:27264
v_and_b32 v236, s54, v156
v_sub_f32 v233, v233, v234
v_mfma_f32_16x16x32_bf16 v[64:67], v[180:183], a[20:23], v[64:67]
v_sub_f32 v235, v235, v236
v_cvt_pk_bf16_f32 v188, v233, v235
v_mfma_f32_16x16x32_bf16 v[68:71], v[176:179], a[20:23], v[68:71]
v_lshlrev_b32 v233, 16, v125
v_lshlrev_b32 v234, 16, v157
v_mfma_f32_16x16x32_bf16 v[68:71], v[180:183], a[24:27], v[68:71]
ds_read_b128 a[100:103], v224 offset:27328
v_and_b32 v235, s54, v125
v_and_b32 v236, s54, v157
v_mfma_f32_16x16x32_bf16 v[72:75], v[176:179], a[24:27], v[72:75]
v_sub_f32 v233, v233, v234
v_sub_f32 v235, v235, v236
v_mfma_f32_16x16x32_bf16 v[72:75], v[180:183], a[28:31], v[72:75]
v_cvt_pk_bf16_f32 v189, v233, v235
v_lshlrev_b32 v233, 16, v126
v_lshlrev_b32 v234, 16, v158
v_mfma_f32_16x16x32_bf16 v[76:79], v[176:179], a[28:31], v[76:79]
ds_read_b128 a[104:107], v224 offset:27392
v_and_b32 v235, s54, v126
v_and_b32 v236, s54, v158
v_mfma_f32_16x16x32_bf16 v[76:79], v[180:183], a[32:35], v[76:79]
v_sub_f32 v233, v233, v234
v_sub_f32 v235, v235, v236
v_mfma_f32_16x16x32_bf16 v[80:83], v[176:179], a[32:35], v[80:83]
v_cvt_pk_bf16_f32 v190, v233, v235
v_lshlrev_b32 v233, 16, v127
v_mfma_f32_16x16x32_bf16 v[80:83], v[180:183], a[36:39], v[80:83]
v_lshlrev_b32 v234, 16, v159
v_and_b32 v235, s54, v127
v_mfma_f32_16x16x32_bf16 v[84:87], v[176:179], a[36:39], v[84:87]
ds_read_b128 a[108:111], v224 offset:27456
v_and_b32 v236, s54, v159
v_sub_f32 v233, v233, v234
v_mfma_f32_16x16x32_bf16 v[84:87], v[180:183], a[40:43], v[84:87]
v_sub_f32 v235, v235, v236
v_cvt_pk_bf16_f32 v191, v233, v235
v_mfma_f32_16x16x32_bf16 v[88:91], v[176:179], a[40:43], v[88:91]
v_mfma_f32_16x16x32_bf16 v[88:91], v[180:183], a[44:47], v[88:91]
ds_read_b128 a[112:115], v224 offset:27520
s_waitcnt vmcnt(13)
s_barrier
v_mfma_f32_16x16x32_bf16 v[92:95], v[176:179], a[44:47], v[92:95]
ds_read_b64_tr_b16 a[120:121], v218 offset:0
ds_read_b64_tr_b16 a[122:123], v218 offset:512
ds_read_b64_tr_b16 v[96:97], v238 offset:0
ds_read_b64_tr_b16 v[98:99], v238 offset:512
v_mfma_f32_16x16x32_bf16 v[92:95], v[180:183], a[48:51], v[92:95]
ds_read_b64_tr_b16 a[124:125], v218 offset:4096
ds_read_b64_tr_b16 a[126:127], v218 offset:4608
ds_read_b64_tr_b16 v[100:101], v238 offset:4096
v_mfma_f32_16x16x32_bf16 v[64:67], v[184:187], a[24:27], v[64:67]
ds_read_b128 a[116:119], v224 offset:27584
ds_read_b64_tr_b16 a[128:129], v218 offset:8192
ds_read_b64_tr_b16 a[130:131], v218 offset:8704
ds_read_b64_tr_b16 v[102:103], v238 offset:4608
v_mfma_f32_16x16x32_bf16 v[64:67], v[188:191], a[28:31], v[64:67]
ds_read_b64_tr_b16 a[132:133], v218 offset:12288
ds_read_b64_tr_b16 a[134:135], v218 offset:12800
ds_read_b64_tr_b16 v[104:105], v238 offset:8192
v_mfma_f32_16x16x32_bf16 v[68:71], v[184:187], a[28:31], v[68:71]
ds_read_b64_tr_b16 v[106:107], v238 offset:8704
ds_read_b64_tr_b16 v[108:109], v238 offset:12288
v_mfma_f32_16x16x32_bf16 v[68:71], v[188:191], a[32:35], v[68:71]
ds_read_b64_tr_b16 v[110:111], v238 offset:12800
v_mfma_f32_16x16x32_bf16 v[72:75], v[184:187], a[32:35], v[72:75]
ds_read_b64_tr_b16 v[112:113], v238 offset:16384
v_mfma_f32_16x16x32_bf16 v[72:75], v[188:191], a[36:39], v[72:75]
ds_read_b64_tr_b16 v[114:115], v238 offset:16896
v_mfma_f32_16x16x32_bf16 v[76:79], v[184:187], a[36:39], v[76:79]
s_waitcnt lgkmcnt(6)
ds_read_b64_tr_b16 v[116:117], v238 offset:20480
ds_read_b64_tr_b16 v[118:119], v238 offset:20992
v_mfma_f32_16x16x32_bf16 v[76:79], v[188:191], a[40:43], v[76:79]
buffer_store_dwordx4 a[120:123], v213, s[24:27], s79 offen offset:0 sc1
v_mfma_f32_16x16x32_bf16 v[80:83], v[184:187], a[40:43], v[80:83]
ds_read_b64_tr_b16 v[120:121], v238 offset:24576
ds_read_b64_tr_b16 v[122:123], v238 offset:25088
v_mfma_f32_16x16x32_bf16 v[80:83], v[188:191], a[44:47], v[80:83]
ds_read_b64_tr_b16 v[124:125], v238 offset:28672
v_mfma_f32_16x16x32_bf16 v[84:87], v[184:187], a[44:47], v[84:87]
buffer_store_dwordx4 a[124:127], v213, s[24:27], s73 offen offset:0 sc1
v_mfma_f32_16x16x32_bf16 v[84:87], v[188:191], a[48:51], v[84:87]
ds_read_b64_tr_b16 v[126:127], v238 offset:29184
v_mfma_f32_16x16x32_bf16 v[88:91], v[184:187], a[48:51], v[88:91]
v_mfma_f32_16x16x32_bf16 v[88:91], v[188:191], a[52:55], v[88:91]
buffer_store_dwordx4 a[128:131], v213, s[24:27], s79 offen offset:1024 sc1
v_mfma_f32_16x16x32_bf16 v[92:95], v[184:187], a[52:55], v[92:95]
v_mfma_f32_16x16x32_bf16 v[92:95], v[188:191], a[56:59], v[92:95]
s_waitcnt lgkmcnt(0)
s_barrier
v_mfma_f32_16x16x32_bf16 v[0:3], v[96:99], a[60:63], v[0:3]
ds_read_b64_tr_b16 v[248:249], v218 offset:0
ds_read_b64_tr_b16 v[250:251], v218 offset:512
ds_read_b64_tr_b16 v[252:253], v218 offset:4096
v_mfma_f32_16x16x32_bf16 v[0:3], v[100:103], a[64:67], v[0:3]
buffer_store_dwordx4 a[132:135], v213, s[24:27], s73 offen offset:1024 sc1
v_mfma_f32_16x16x32_bf16 v[4:7], v[96:99], a[64:67], v[4:7]
ds_read_b128 a[0:3], v204 offset:27712
ds_read_b64_tr_b16 v[254:255], v218 offset:4608
v_mfma_f32_16x16x32_bf16 v[4:7], v[100:103], a[68:71], v[4:7]
v_mfma_f32_16x16x32_bf16 v[8:11], v[96:99], a[68:71], v[8:11]
buffer_store_dword v223, v222, s[32:35], s60 offen sc1
v_mfma_f32_16x16x32_bf16 v[8:11], v[100:103], a[72:75], v[8:11]
ds_read_b128 a[4:7], v204 offset:27776
v_mfma_f32_16x16x32_bf16 v[12:15], v[96:99], a[72:75], v[12:15]
v_mfma_f32_16x16x32_bf16 v[12:15], v[100:103], a[76:79], v[12:15]
buffer_load_dwordx2 v[214:215], v220, s[68:71], s89 offen sc1
v_mfma_f32_16x16x32_bf16 v[16:19], v[96:99], a[76:79], v[16:19]
s_waitcnt lgkmcnt(1)
v_lshlrev_b32 v233, 16, v248
v_lshlrev_b32 v234, 16, v252
v_and_b32 v235, s54, v248
v_and_b32 v236, s54, v252
v_sub_f32 v233, v233, v234
v_sub_f32 v235, v235, v236
v_cvt_pk_bf16_f32 v240, v233, v235
v_lshlrev_b32 v233, 16, v249
v_lshlrev_b32 v234, 16, v253
v_and_b32 v235, s54, v249
v_and_b32 v236, s54, v253
v_sub_f32 v233, v233, v234
v_sub_f32 v235, v235, v236
v_cvt_pk_bf16_f32 v241, v233, v235
v_mfma_f32_16x16x32_bf16 v[16:19], v[100:103], a[80:83], v[16:19]
ds_read_b128 a[8:11], v204 offset:27840
v_lshlrev_b32 v233, 16, v250
v_lshlrev_b32 v234, 16, v254
v_mfma_f32_16x16x32_bf16 v[20:23], v[96:99], a[80:83], v[20:23]
v_and_b32 v235, s54, v250
v_and_b32 v236, s54, v254
v_mfma_f32_16x16x32_bf16 v[20:23], v[100:103], a[84:87], v[20:23]
v_sub_f32 v233, v233, v234
v_sub_f32 v235, v235, v236
v_mfma_f32_16x16x32_bf16 v[24:27], v[96:99], a[84:87], v[24:27]
ds_read_b128 a[12:15], v204 offset:27904
v_cvt_pk_bf16_f32 v242, v233, v235
v_lshlrev_b32 v233, 16, v251
v_mfma_f32_16x16x32_bf16 v[24:27], v[100:103], a[88:91], v[24:27]
v_lshlrev_b32 v234, 16, v255
v_and_b32 v235, s54, v251
v_mfma_f32_16x16x32_bf16 v[28:31], v[96:99], a[88:91], v[28:31]
v_and_b32 v236, s54, v255
v_sub_f32 v233, v233, v234
v_mfma_f32_16x16x32_bf16 v[28:31], v[100:103], a[92:95], v[28:31]
v_sub_f32 v235, v235, v236
v_cvt_pk_bf16_f32 v243, v233, v235
v_mfma_f32_16x16x32_bf16 v[0:3], v[104:107], a[68:71], v[0:3]
ds_read_b128 a[16:19], v204 offset:27968
ds_read_b64_tr_b16 v[248:249], v218 offset:8192
ds_read_b64_tr_b16 v[250:251], v218 offset:8704
ds_read_b64_tr_b16 v[252:253], v218 offset:12288
v_mfma_f32_16x16x32_bf16 v[0:3], v[108:111], a[72:75], v[0:3]
buffer_store_dwordx4 v[240:243], v213, s[24:27], s74 offen offset:0 sc1
v_mfma_f32_16x16x32_bf16 v[4:7], v[104:107], a[72:75], v[4:7]
ds_read_b64_tr_b16 v[254:255], v218 offset:12800
v_mfma_f32_16x16x32_bf16 v[4:7], v[108:111], a[76:79], v[4:7]
ds_read_b128 a[20:23], v204 offset:28032
v_mfma_f32_16x16x32_bf16 v[8:11], v[104:107], a[76:79], v[8:11]
ds_read_b128 v[192:195], v205 offset:27712
ds_read_b128 v[196:199], v206 offset:27200
ds_read_b32 v230, v207 offset:27712
v_mfma_f32_16x16x32_bf16 v[8:11], v[108:111], a[80:83], v[8:11]
ds_read_b32 v231, v207 offset:27264
v_mfma_f32_16x16x32_bf16 v[12:15], v[104:107], a[80:83], v[12:15]
v_mfma_f32_16x16x32_bf16 v[12:15], v[108:111], a[84:87], v[12:15]
ds_read_b128 a[24:27], v204 offset:28096
s_waitcnt lgkmcnt(6)
v_lshlrev_b32 v233, 16, v248
v_lshlrev_b32 v234, 16, v252
v_and_b32 v235, s54, v248
v_and_b32 v236, s54, v252
v_sub_f32 v233, v233, v234
v_sub_f32 v235, v235, v236
v_cvt_pk_bf16_f32 v244, v233, v235
v_lshlrev_b32 v233, 16, v249
v_lshlrev_b32 v234, 16, v253
v_and_b32 v235, s54, v249
v_and_b32 v236, s54, v253
v_sub_f32 v233, v233, v234
v_sub_f32 v235, v235, v236
v_cvt_pk_bf16_f32 v245, v233, v235
v_lshlrev_b32 v233, 16, v250
v_lshlrev_b32 v234, 16, v254
v_and_b32 v235, s54, v250
v_mfma_f32_16x16x32_bf16 v[16:19], v[104:107], a[84:87], v[16:19]
v_and_b32 v236, s54, v254
v_sub_f32 v233, v233, v234
v_sub_f32 v235, v235, v236
v_mfma_f32_16x16x32_bf16 v[16:19], v[108:111], a[88:91], v[16:19]
v_cvt_pk_bf16_f32 v246, v233, v235
v_lshlrev_b32 v233, 16, v251
v_lshlrev_b32 v234, 16, v255
v_mfma_f32_16x16x32_bf16 v[20:23], v[104:107], a[88:91], v[20:23]
v_and_b32 v235, s54, v251
v_and_b32 v236, s54, v255
v_sub_f32 v233, v233, v234
v_mfma_f32_16x16x32_bf16 v[20:23], v[108:111], a[92:95], v[20:23]
ds_read_b128 a[28:31], v204 offset:28160
v_sub_f32 v235, v235, v236
v_cvt_pk_bf16_f32 v247, v233, v235
s_waitcnt lgkmcnt(4)
v_lshlrev_b32 v200, 16, v192
v_lshlrev_b32 v201, 16, v196
v_and_b32 v202, s54, v192
v_and_b32 v203, s54, v196
v_sub_f32 v200, v200, v201
v_sub_f32 v202, v202, v203
v_cvt_pk_bf16_f32 v192, v200, v202
v_lshlrev_b32 v200, 16, v193
v_lshlrev_b32 v201, 16, v197
v_and_b32 v202, s54, v193
v_and_b32 v203, s54, v197
v_sub_f32 v200, v200, v201
v_sub_f32 v202, v202, v203
v_mfma_f32_16x16x32_bf16 v[24:27], v[104:107], a[92:95], v[24:27]
s_waitcnt vmcnt(12)
s_barrier
v_cvt_pk_bf16_f32 v193, v200, v202
v_lshlrev_b32 v200, 16, v194
v_mfma_f32_16x16x32_bf16 v[24:27], v[108:111], a[96:99], v[24:27]
buffer_store_dwordx4 v[244:247], v213, s[24:27], s74 offen offset:1024 sc1
v_mfma_f32_16x16x32_bf16 v[28:31], v[104:107], a[96:99], v[28:31]
ds_read_b64_tr_b16 v[128:129], v238 offset:32768
ds_read_b128 a[32:35], v224 offset:27712
v_lshlrev_b32 v201, 16, v198
v_and_b32 v202, s54, v194
v_and_b32 v203, s54, v198
v_sub_f32 v200, v200, v201
v_sub_f32 v202, v202, v203
v_mfma_f32_16x16x32_bf16 v[28:31], v[108:111], a[100:103], v[28:31]
s_add_u32 m0, s85, 0
ds_read_b64_tr_b16 v[130:131], v238 offset:33280
v_cvt_pk_bf16_f32 v194, v200, v202
v_lshlrev_b32 v200, 16, v195
v_mfma_f32_16x16x32_bf16 v[0:3], v[112:115], a[76:79], v[0:3]
s_add_u32 s86, s84, 0
v_lshlrev_b32 v201, 16, v199
v_and_b32 v202, s54, v195
v_mfma_f32_16x16x32_bf16 v[0:3], v[116:119], a[80:83], v[0:3]
buffer_load_dwordx4 v237, s[64:67], s86 offen lds
v_mfma_f32_16x16x32_bf16 v[4:7], v[112:115], a[80:83], v[4:7]
s_add_u32 m0, s85, 4096
ds_read_b64_tr_b16 v[132:133], v238 offset:36864
ds_read_b64_tr_b16 v[134:135], v238 offset:37376
ds_read_b128 a[36:39], v224 offset:27776
v_and_b32 v203, s54, v199
v_sub_f32 v200, v200, v201
v_sub_f32 v202, v202, v203
v_cvt_pk_bf16_f32 v195, v200, v202
ds_write_b128 v205, v[192:195] offset:28224
v_mfma_f32_16x16x32_bf16 v[4:7], v[116:119], a[84:87], v[4:7]
s_waitcnt lgkmcnt(9)
v_lshlrev_b32 v200, 16, v230
v_mfma_f32_16x16x32_bf16 v[8:11], v[112:115], a[84:87], v[8:11]
s_add_u32 s86, s84, 524288
ds_read_b64_tr_b16 v[136:137], v238 offset:40960
v_lshlrev_b32 v201, 16, v231
v_and_b32 v202, s54, v230
v_mfma_f32_16x16x32_bf16 v[8:11], v[116:119], a[88:91], v[8:11]
buffer_load_dwordx4 v237, s[64:67], s86 offen lds
v_mfma_f32_16x16x32_bf16 v[12:15], v[112:115], a[88:91], v[12:15]
s_add_u32 m0, s85, 8192
ds_read_b64_tr_b16 v[138:139], v238 offset:41472
ds_read_b128 a[40:43], v224 offset:27840
v_and_b32 v203, s54, v231
v_sub_f32 v200, v200, v201
v_sub_f32 v202, v202, v203
v_cvt_pk_bf16_f32 v230, v200, v202
v_mfma_f32_16x16x32_bf16 v[12:15], v[116:119], a[92:95], v[12:15]
s_add_u32 s86, s84, 1048576
ds_read_b64_tr_b16 v[140:141], v238 offset:45056
ds_write_b32 v207, v230 offset:28224
ds_read_b128 v[192:195], v205 offset:30912
ds_read_b128 v[196:199], v225 offset:30400
v_mfma_f32_16x16x32_bf16 v[16:19], v[112:115], a[92:95], v[16:19]
ds_read_b64_tr_b16 v[142:143], v238 offset:45568
v_mfma_f32_16x16x32_bf16 v[16:19], v[116:119], a[96:99], v[16:19]
buffer_load_dwordx4 v237, s[64:67], s86 offen lds
v_mfma_f32_16x16x32_bf16 v[20:23], v[112:115], a[96:99], v[20:23]
s_add_u32 m0, s85, 12288
ds_read_b64_tr_b16 v[144:145], v238 offset:49152
ds_read_b128 a[44:47], v224 offset:27904
v_mfma_f32_16x16x32_bf16 v[20:23], v[116:119], a[100:103], v[20:23]
s_add_u32 s86, s84, 1572864
ds_read_b64_tr_b16 v[146:147], v238 offset:49664
v_mfma_f32_16x16x32_bf16 v[24:27], v[112:115], a[100:103], v[24:27]
buffer_load_dwordx4 v237, s[64:67], s86 offen lds
v_mfma_f32_16x16x32_bf16 v[24:27], v[116:119], a[104:107], v[24:27]
ds_read_b64_tr_b16 v[148:149], v238 offset:53248
ds_read_b128 a[48:51], v224 offset:27968
s_waitcnt lgkmcnt(6)
v_lshlrev_b32 v200, 16, v192
v_lshlrev_b32 v201, 16, v196
v_and_b32 v202, s54, v192
v_and_b32 v203, s54, v196
v_sub_f32 v200, v200, v201
v_sub_f32 v202, v202, v203
v_cvt_pk_bf16_f32 v192, v200, v202
v_lshlrev_b32 v200, 16, v193
v_lshlrev_b32 v201, 16, v197
v_and_b32 v202, s54, v193
v_and_b32 v203, s54, v197
v_sub_f32 v200, v200, v201
v_mfma_f32_16x16x32_bf16 v[28:31], v[112:115], a[104:107], v[28:31]
s_add_u32 m0, s85, 16384
ds_read_b64_tr_b16 v[150:151], v238 offset:53760
v_sub_f32 v202, v202, v203
v_cvt_pk_bf16_f32 v193, v200, v202
v_mfma_f32_16x16x32_bf16 v[28:31], v[116:119], a[108:111], v[28:31]
s_add_u32 s86, s84, 2097152
v_lshlrev_b32 v200, 16, v194
v_lshlrev_b32 v201, 16, v198
v_mfma_f32_16x16x32_bf16 v[0:3], v[120:123], a[84:87], v[0:3]
buffer_load_dwordx4 v237, s[64:67], s86 offen lds
v_mfma_f32_16x16x32_bf16 v[0:3], v[124:127], a[88:91], v[0:3]
s_add_u32 m0, s85, 20480
ds_read_b64_tr_b16 v[152:153], v238 offset:57344
ds_read_b64_tr_b16 v[154:155], v238 offset:57856
ds_read_b128 a[52:55], v224 offset:28032
v_and_b32 v202, s54, v194
v_and_b32 v203, s54, v198
v_sub_f32 v200, v200, v201
v_sub_f32 v202, v202, v203
v_cvt_pk_bf16_f32 v194, v200, v202
v_mfma_f32_16x16x32_bf16 v[4:7], v[120:123], a[88:91], v[4:7]
v_lshlrev_b32 v200, 16, v195
v_lshlrev_b32 v201, 16, v199
v_mfma_f32_16x16x32_bf16 v[4:7], v[124:127], a[92:95], v[4:7]
s_add_u32 s86, s84, 2621440
ds_read_b64_tr_b16 v[156:157], v238 offset:61440
v_and_b32 v202, s54, v195
v_and_b32 v203, s54, v199
v_mfma_f32_16x16x32_bf16 v[8:11], v[120:123], a[92:95], v[8:11]
buffer_load_dwordx4 v237, s[64:67], s86 offen lds
v_mfma_f32_16x16x32_bf16 v[8:11], v[124:127], a[96:99], v[8:11]
s_add_u32 m0, s85, 24576
ds_read_b64_tr_b16 v[158:159], v238 offset:61952
v_sub_f32 v200, v200, v201
v_sub_f32 v202, v202, v203
v_cvt_pk_bf16_f32 v195, v200, v202
ds_write_b128 v205, v[192:195] offset:31424
v_mfma_f32_16x16x32_bf16 v[12:15], v[120:123], a[96:99], v[12:15]
s_add_u32 s86, s84, 3145728
v_mfma_f32_16x16x32_bf16 v[12:15], v[124:127], a[100:103], v[12:15]
v_mfma_f32_16x16x32_bf16 v[16:19], v[120:123], a[100:103], v[16:19]
buffer_load_dwordx4 v237, s[64:67], s86 offen lds
v_mfma_f32_16x16x32_bf16 v[16:19], v[124:127], a[104:107], v[16:19]
s_add_u32 m0, s85, 28672
v_mfma_f32_16x16x32_bf16 v[20:23], v[120:123], a[104:107], v[20:23]
s_add_u32 s86, s84, 3670016
v_mfma_f32_16x16x32_bf16 v[20:23], v[124:127], a[108:111], v[20:23]
buffer_load_dwordx4 v237, s[64:67], s86 offen lds
v_mfma_f32_16x16x32_bf16 v[24:27], v[120:123], a[108:111], v[24:27]
v_mfma_f32_16x16x32_bf16 v[24:27], v[124:127], a[112:115], v[24:27]
v_mfma_f32_16x16x32_bf16 v[28:31], v[120:123], a[112:115], v[28:31]
v_mfma_f32_16x16x32_bf16 v[28:31], v[124:127], a[116:119], v[28:31]
s_waitcnt lgkmcnt(0)
s_waitcnt vmcnt(16)
s_barrier
v_mfma_f32_16x16x32_bf16 v[32:35], v[128:131], a[0:3], v[32:35]
s_add_u32 m0, s85, 32768
v_lshlrev_b32 v233, 16, v96
v_lshlrev_b32 v234, 16, v128
v_and_b32 v235, s54, v96
v_mfma_f32_16x16x32_bf16 v[32:35], v[132:135], a[4:7], v[32:35]
s_add_u32 s86, s84, 262144
v_and_b32 v236, s54, v128
v_sub_f32 v233, v233, v234
v_mfma_f32_16x16x32_bf16 v[36:39], v[128:131], a[4:7], v[36:39]
buffer_load_dwordx4 v237, s[64:67], s86 offen lds
v_mfma_f32_16x16x32_bf16 v[36:39], v[132:135], a[8:11], v[36:39]
s_add_u32 m0, s85, 36864
ds_read_b128 a[60:63], v204 offset:28224
v_sub_f32 v235, v235, v236
v_cvt_pk_bf16_f32 v160, v233, v235
v_lshlrev_b32 v233, 16, v97
v_lshlrev_b32 v234, 16, v129
v_and_b32 v235, s54, v97
v_mfma_f32_16x16x32_bf16 v[40:43], v[128:131], a[8:11], v[40:43]
s_add_u32 s86, s84, 786432
ds_read_b128 a[64:67], v204 offset:28288
v_and_b32 v236, s54, v129
v_sub_f32 v233, v233, v234
v_mfma_f32_16x16x32_bf16 v[40:43], v[132:135], a[12:15], v[40:43]
buffer_load_dwordx4 v237, s[64:67], s86 offen lds
v_mfma_f32_16x16x32_bf16 v[44:47], v[128:131], a[12:15], v[44:47]
s_add_u32 m0, s85, 40960
v_sub_f32 v235, v235, v236
v_cvt_pk_bf16_f32 v161, v233, v235
v_lshlrev_b32 v233, 16, v98
v_lshlrev_b32 v234, 16, v130
v_and_b32 v235, s54, v98
v_mfma_f32_16x16x32_bf16 v[44:47], v[132:135], a[16:19], v[44:47]
s_add_u32 s86, s84, 1310720
ds_read_b128 a[68:71], v204 offset:28352
v_and_b32 v236, s54, v130
v_sub_f32 v233, v233, v234
v_mfma_f32_16x16x32_bf16 v[48:51], v[128:131], a[16:19], v[48:51]
buffer_load_dwordx4 v237, s[64:67], s86 offen lds
v_mfma_f32_16x16x32_bf16 v[48:51], v[132:135], a[20:23], v[48:51]
s_add_u32 m0, s85, 45056
v_sub_f32 v235, v235, v236
v_cvt_pk_bf16_f32 v162, v233, v235
v_lshlrev_b32 v233, 16, v99
v_lshlrev_b32 v234, 16, v131
v_and_b32 v235, s54, v99
v_mfma_f32_16x16x32_bf16 v[52:55], v[128:131], a[20:23], v[52:55]
s_add_u32 s86, s84, 1835008
ds_read_b128 a[72:75], v204 offset:28416
v_and_b32 v236, s54, v131
v_sub_f32 v233, v233, v234
v_mfma_f32_16x16x32_bf16 v[52:55], v[132:135], a[24:27], v[52:55]
buffer_load_dwordx4 v237, s[64:67], s86 offen lds
v_mfma_f32_16x16x32_bf16 v[56:59], v[128:131], a[24:27], v[56:59]
s_add_u32 m0, s85, 49152
v_sub_f32 v235, v235, v236
v_cvt_pk_bf16_f32 v163, v233, v235
v_lshlrev_b32 v233, 16, v100
v_lshlrev_b32 v234, 16, v132
v_and_b32 v235, s54, v100
v_mfma_f32_16x16x32_bf16 v[56:59], v[132:135], a[28:31], v[56:59]
s_add_u32 s86, s84, 2359296
ds_read_b128 a[76:79], v204 offset:28480
v_and_b32 v236, s54, v132
v_sub_f32 v233, v233, v234
v_mfma_f32_16x16x32_bf16 v[60:63], v[128:131], a[28:31], v[60:63]
buffer_load_dwordx4 v237, s[64:67], s86 offen lds
v_mfma_f32_16x16x32_bf16 v[60:63], v[132:135], a[32:35], v[60:63]
s_add_u32 m0, s85, 53248
v_sub_f32 v235, v235, v236
v_cvt_pk_bf16_f32 v164, v233, v235
v_lshlrev_b32 v233, 16, v101
v_lshlrev_b32 v234, 16, v133
v_and_b32 v235, s54, v101
v_mfma_f32_16x16x32_bf16 v[32:35], v[136:139], a[8:11], v[32:35]
s_add_u32 s86, s84, 2883584
ds_read_b128 a[80:83], v204 offset:28544
v_and_b32 v236, s54, v133
v_sub_f32 v233, v233, v234
v_mfma_f32_16x16x32_bf16 v[32:35], v[140:143], a[12:15], v[32:35]
buffer_load_dwordx4 v237, s[64:67], s86 offen lds
v_mfma_f32_16x16x32_bf16 v[36:39], v[136:139], a[12:15], v[36:39]
s_add_u32 m0, s85, 57344
ds_read_b128 a[84:87], v204 offset:28608
v_sub_f32 v235, v235, v236
v_cvt_pk_bf16_f32 v165, v233, v235
v_lshlrev_b32 v233, 16, v102
v_lshlrev_b32 v234, 16, v134
v_and_b32 v235, s54, v102
v_mfma_f32_16x16x32_bf16 v[36:39], v[140:143], a[16:19], v[36:39]
s_add_u32 s86, s84, 3407872
v_and_b32 v236, s54, v134
v_sub_f32 v233, v233, v234
v_mfma_f32_16x16x32_bf16 v[40:43], v[136:139], a[16:19], v[40:43]
buffer_load_dwordx4 v237, s[64:67], s86 offen lds
v_mfma_f32_16x16x32_bf16 v[40:43], v[140:143], a[20:23], v[40:43]
s_add_u32 m0, s85, 61440
ds_read_b128 a[88:91], v204 offset:28672
v_sub_f32 v235, v235, v236
v_cvt_pk_bf16_f32 v166, v233, v235
v_lshlrev_b32 v233, 16, v103
v_lshlrev_b32 v234, 16, v135
v_and_b32 v235, s54, v103
v_mfma_f32_16x16x32_bf16 v[44:47], v[136:139], a[20:23], v[44:47]
s_add_u32 s86, s84, 3932160
v_and_b32 v236, s54, v135
v_sub_f32 v233, v233, v234
v_mfma_f32_16x16x32_bf16 v[44:47], v[140:143], a[24:27], v[44:47]
buffer_load_dwordx4 v237, s[64:67], s86 offen lds
v_mfma_f32_16x16x32_bf16 v[48:51], v[136:139], a[24:27], v[48:51]
s_add_u32 s84, s84, 131072
ds_read_b128 a[92:95], v224 offset:28224
v_sub_f32 v235, v235, v236
v_cvt_pk_bf16_f32 v167, v233, v235
v_lshlrev_b32 v233, 16, v104
v_lshlrev_b32 v234, 16, v136
v_and_b32 v235, s54, v104
v_mfma_f32_16x16x32_bf16 v[48:51], v[140:143], a[28:31], v[48:51]
s_add_u32 m0, s53, 27200
v_and_b32 v236, s54, v136
v_sub_f32 v233, v233, v234
v_mfma_f32_16x16x32_bf16 v[52:55], v[136:139], a[28:31], v[52:55]
buffer_load_dwordx4 v208, s[20:23], s50 offen lds
v_mfma_f32_16x16x32_bf16 v[52:55], v[140:143], a[32:35], v[52:55]
ds_read_b128 a[96:99], v224 offset:28288
v_sub_f32 v235, v235, v236
v_cvt_pk_bf16_f32 v168, v233, v235
v_lshlrev_b32 v233, 16, v105
v_lshlrev_b32 v234, 16, v137
v_and_b32 v235, s54, v105
v_mfma_f32_16x16x32_bf16 v[56:59], v[136:139], a[32:35], v[56:59]
s_add_u32 m0, s53, 33600
v_and_b32 v236, s54, v137
v_sub_f32 v233, v233, v234
v_mfma_f32_16x16x32_bf16 v[56:59], v[140:143], a[36:39], v[56:59]
buffer_load_dwordx4 v209, s[20:23], s50 offen lds
v_mfma_f32_16x16x32_bf16 v[60:63], v[136:139], a[36:39], v[60:63]
ds_read_b128 a[100:103], v224 offset:28352
v_sub_f32 v235, v235, v236
v_cvt_pk_bf16_f32 v169, v233, v235
v_lshlrev_b32 v233, 16, v106
v_lshlrev_b32 v234, 16, v138
v_and_b32 v235, s54, v106
v_mfma_f32_16x16x32_bf16 v[60:63], v[140:143], a[40:43], v[60:63]
s_add_u32 m0, s53, 40000
v_and_b32 v236, s54, v138
v_sub_f32 v233, v233, v234
v_mfma_f32_16x16x32_bf16 v[32:35], v[144:147], a[16:19], v[32:35]
buffer_load_dwordx4 v210, s[20:23], s50 offen lds
v_mfma_f32_16x16x32_bf16 v[32:35], v[148:151], a[20:23], v[32:35]
ds_read_b128 a[104:107], v224 offset:28416
v_sub_f32 v235, v235, v236
v_cvt_pk_bf16_f32 v170, v233, v235
v_lshlrev_b32 v233, 16, v107
v_lshlrev_b32 v234, 16, v139
v_and_b32 v235, s54, v107
v_mfma_f32_16x16x32_bf16 v[36:39], v[144:147], a[20:23], v[36:39]
s_add_u32 m0, s53, 46400
v_and_b32 v236, s54, v139
v_sub_f32 v233, v233, v234
v_mfma_f32_16x16x32_bf16 v[36:39], v[148:151], a[24:27], v[36:39]
buffer_load_dwordx4 v211, s[20:23], s50 offen lds
v_mfma_f32_16x16x32_bf16 v[40:43], v[144:147], a[24:27], v[40:43]
ds_read_b128 a[108:111], v224 offset:28480
v_sub_f32 v235, v235, v236
v_cvt_pk_bf16_f32 v171, v233, v235
v_lshlrev_b32 v233, 16, v108
v_lshlrev_b32 v234, 16, v140
v_and_b32 v235, s54, v108
v_mfma_f32_16x16x32_bf16 v[40:43], v[148:151], a[28:31], v[40:43]
s_add_u32 m0, s55, 27200
v_and_b32 v236, s54, v140
v_sub_f32 v233, v233, v234
v_mfma_f32_16x16x32_bf16 v[44:47], v[144:147], a[28:31], v[44:47]
buffer_load_dword v212, s[20:23], s50 offen lds
v_mfma_f32_16x16x32_bf16 v[44:47], v[148:151], a[32:35], v[44:47]
ds_read_b128 a[112:115], v224 offset:28544
v_sub_f32 v235, v235, v236
v_cvt_pk_bf16_f32 v172, v233, v235
v_lshlrev_b32 v233, 16, v109
v_lshlrev_b32 v234, 16, v141
v_and_b32 v235, s54, v109
v_mfma_f32_16x16x32_bf16 v[48:51], v[144:147], a[32:35], v[48:51]
v_and_b32 v236, s54, v141
v_sub_f32 v233, v233, v234
v_mfma_f32_16x16x32_bf16 v[48:51], v[148:151], a[36:39], v[48:51]
ds_read_b128 a[116:119], v224 offset:28608
v_sub_f32 v235, v235, v236
v_cvt_pk_bf16_f32 v173, v233, v235
v_mfma_f32_16x16x32_bf16 v[52:55], v[144:147], a[36:39], v[52:55]
v_lshlrev_b32 v233, 16, v110
v_lshlrev_b32 v234, 16, v142
v_and_b32 v235, s54, v110
v_mfma_f32_16x16x32_bf16 v[52:55], v[148:151], a[40:43], v[52:55]
v_and_b32 v236, s54, v142
v_sub_f32 v233, v233, v234
v_mfma_f32_16x16x32_bf16 v[56:59], v[144:147], a[40:43], v[56:59]
v_sub_f32 v235, v235, v236
v_cvt_pk_bf16_f32 v174, v233, v235
v_mfma_f32_16x16x32_bf16 v[56:59], v[148:151], a[44:47], v[56:59]
v_lshlrev_b32 v233, 16, v111
v_lshlrev_b32 v234, 16, v143
v_and_b32 v235, s54, v111
v_mfma_f32_16x16x32_bf16 v[60:63], v[144:147], a[44:47], v[60:63]
v_and_b32 v236, s54, v143
v_sub_f32 v233, v233, v234
v_mfma_f32_16x16x32_bf16 v[60:63], v[148:151], a[48:51], v[60:63]
v_sub_f32 v235, v235, v236
v_cvt_pk_bf16_f32 v175, v233, v235
v_mfma_f32_16x16x32_bf16 v[32:35], v[152:155], a[24:27], v[32:35]
v_lshlrev_b32 v233, 16, v112
v_lshlrev_b32 v234, 16, v144
v_and_b32 v235, s54, v112
v_mfma_f32_16x16x32_bf16 v[36:39], v[152:155], a[28:31], v[36:39]
v_and_b32 v236, s54, v144
v_sub_f32 v233, v233, v234
v_mfma_f32_16x16x32_bf16 v[40:43], v[152:155], a[32:35], v[40:43]
v_sub_f32 v235, v235, v236
v_cvt_pk_bf16_f32 v176, v233, v235
v_mfma_f32_16x16x32_bf16 v[44:47], v[152:155], a[36:39], v[44:47]
v_lshlrev_b32 v233, 16, v113
v_lshlrev_b32 v234, 16, v145
v_and_b32 v235, s54, v113
v_mfma_f32_16x16x32_bf16 v[48:51], v[152:155], a[40:43], v[48:51]
v_and_b32 v236, s54, v145
v_sub_f32 v233, v233, v234
v_mfma_f32_16x16x32_bf16 v[52:55], v[152:155], a[44:47], v[52:55]
v_sub_f32 v235, v235, v236
v_cvt_pk_bf16_f32 v177, v233, v235
v_mfma_f32_16x16x32_bf16 v[56:59], v[152:155], a[48:51], v[56:59]
v_mfma_f32_16x16x32_bf16 v[60:63], v[152:155], a[52:55], v[60:63]
s_waitcnt lgkmcnt(0)
s_waitcnt vmcnt(21)
s_cmp_lg_u32 s44, 0
s_cbranch_scc1 LM_tok
LM_tchk:
v_min_u32 v200, v214, v215
s_add_u32 s90, s90, 1
v_cmp_eq_u32 vcc, 0, v200
s_cmp_ge_u32 s90, 4000000
s_cbranch_scc1 LM_tok
s_cbranch_vccz LM_tok
s_sleep 8
buffer_load_dwordx2 v[214:215], v220, s[68:71], s89 offen sc1
s_waitcnt vmcnt(0)
s_branch LM_tchk
LM_tok:
s_barrier
s_mov_b64 exec, 1
buffer_store_dwordx2 v[214:215], v220, s[36:39], s88 offen sc1
s_mov_b64 exec, -1
v_mfma_f32_16x16x32_bf16 v[64:67], v[160:163], a[60:63], v[64:67]
v_lshlrev_b32 v233, 16, v114
v_lshlrev_b32 v234, 16, v146
v_and_b32 v235, s54, v114
v_mfma_f32_16x16x32_bf16 v[64:67], v[164:167], a[64:67], v[64:67]
v_and_b32 v236, s54, v146
v_sub_f32 v233, v233, v234
v_mfma_f32_16x16x32_bf16 v[68:71], v[160:163], a[64:67], v[68:71]
ds_read_b128 a[0:3], v204 offset:0
v_sub_f32 v235, v235, v236
v_cvt_pk_bf16_f32 v178, v233, v235
v_mfma_f32_16x16x32_bf16 v[68:71], v[164:167], a[68:71], v[68:71]
v_lshlrev_b32 v233, 16, v115
v_lshlrev_b32 v234, 16, v147
v_and_b32 v235, s54, v115
v_mfma_f32_16x16x32_bf16 v[72:75], v[160:163], a[68:71], v[72:75]
v_and_b32 v236, s54, v147
v_sub_f32 v233, v233, v234
v_mfma_f32_16x16x32_bf16 v[72:75], v[164:167], a[72:75], v[72:75]
ds_read_b128 a[4:7], v204 offset:64
v_sub_f32 v235, v235, v236
v_cvt_pk_bf16_f32 v179, v233, v235
v_mfma_f32_16x16x32_bf16 v[76:79], v[160:163], a[72:75], v[76:79]
v_lshlrev_b32 v233, 16, v116
v_lshlrev_b32 v234, 16, v148
v_and_b32 v235, s54, v116
v_mfma_f32_16x16x32_bf16 v[76:79], v[164:167], a[76:79], v[76:79]
v_and_b32 v236, s54, v148
v_sub_f32 v233, v233, v234
v_mfma_f32_16x16x32_bf16 v[80:83], v[160:163], a[76:79], v[80:83]
ds_read_b128 a[8:11], v204 offset:128
v_sub_f32 v235, v235, v236
v_cvt_pk_bf16_f32 v180, v233, v235
v_mfma_f32_16x16x32_bf16 v[80:83], v[164:167], a[80:83], v[80:83]
v_lshlrev_b32 v233, 16, v117
v_lshlrev_b32 v234, 16, v149
v_and_b32 v235, s54, v117
v_mfma_f32_16x16x32_bf16 v[84:87], v[160:163], a[80:83], v[84:87]
v_and_b32 v236, s54, v149
v_sub_f32 v233, v233, v234
v_mfma_f32_16x16x32_bf16 v[84:87], v[164:167], a[84:87], v[84:87]
v_sub_f32 v235, v235, v236
v_cvt_pk_bf16_f32 v181, v233, v235
v_mfma_f32_16x16x32_bf16 v[88:91], v[160:163], a[84:87], v[88:91]
ds_read_b128 a[12:15], v204 offset:192
v_lshlrev_b32 v233, 16, v118
v_lshlrev_b32 v234, 16, v150
v_and_b32 v235, s54, v118
v_mfma_f32_16x16x32_bf16 v[88:91], v[164:167], a[88:91], v[88:91]
v_and_b32 v236, s54, v150
v_sub_f32 v233, v233, v234
v_mfma_f32_16x16x32_bf16 v[92:95], v[160:163], a[88:91], v[92:95]
v_sub_f32 v235, v235, v236
v_cvt_pk_bf16_f32 v182, v233, v235
v_mfma_f32_16x16x32_bf16 v[92:95], v[164:167], a[92:95], v[92:95]
ds_read_b128 a[16:19], v204 offset:256
v_lshlrev_b32 v233, 16, v119
v_lshlrev_b32 v234, 16, v151
v_and_b32 v235, s54, v119
v_mfma_f32_16x16x32_bf16 v[64:67], v[168:171], a[68:71], v[64:67]
v_and_b32 v236, s54, v151
v_sub_f32 v233, v233, v234
v_mfma_f32_16x16x32_bf16 v[64:67], v[172:175], a[72:75], v[64:67]
v_sub_f32 v235, v235, v236
v_cvt_pk_bf16_f32 v183, v233, v235
v_mfma_f32_16x16x32_bf16 v[68:71], v[168:171], a[72:75], v[68:71]
ds_read_b128 a[20:23], v204 offset:320
v_lshlrev_b32 v233, 16, v120
v_lshlrev_b32 v234, 16, v152
v_and_b32 v235, s54, v120
v_mfma_f32_16x16x32_bf16 v[68:71], v[172:175], a[76:79], v[68:71]
v_and_b32 v236, s54, v152
v_sub_f32 v233, v233, v234
v_mfma_f32_16x16x32_bf16 v[72:75], v[168:171], a[76:79], v[72:75]
v_sub_f32 v235, v235, v236
v_cvt_pk_bf16_f32 v184, v233, v235
v_mfma_f32_16x16x32_bf16 v[72:75], v[172:175], a[80:83], v[72:75]
v_lshlrev_b32 v233, 16, v121
v_lshlrev_b32 v234, 16, v153
v_mfma_f32_16x16x32_bf16 v[76:79], v[168:171], a[80:83], v[76:79]
ds_read_b128 a[24:27], v204 offset:384
v_and_b32 v235, s54, v121
v_and_b32 v236, s54, v153
v_mfma_f32_16x16x32_bf16 v[76:79], v[172:175], a[84:87], v[76:79]
v_sub_f32 v233, v233, v234
v_sub_f32 v235, v235, v236
v_mfma_f32_16x16x32_bf16 v[80:83], v[168:171], a[84:87], v[80:83]
v_cvt_pk_bf16_f32 v185, v233, v235
v_lshlrev_b32 v233, 16, v122
v_lshlrev_b32 v234, 16, v154
v_mfma_f32_16x16x32_bf16 v[80:83], v[172:175], a[88:91], v[80:83]
ds_read_b128 a[28:31], v204 offset:448
v_and_b32 v235, s54, v122
v_and_b32 v236, s54, v154
v_mfma_f32_16x16x32_bf16 v[84:87], v[168:171], a[88:91], v[84:87]
v_sub_f32 v233, v233, v234
v_sub_f32 v235, v235, v236
v_mfma_f32_16x16x32_bf16 v[84:87], v[172:175], a[92:95], v[84:87]
v_cvt_pk_bf16_f32 v186, v233, v235
v_lshlrev_b32 v233, 16, v123
v_mfma_f32_16x16x32_bf16 v[88:91], v[168:171], a[92:95], v[88:91]
ds_read_b128 a[32:35], v224 offset:0
v_lshlrev_b32 v234, 16, v155
v_and_b32 v235, s54, v123
v_mfma_f32_16x16x32_bf16 v[88:91], v[172:175], a[96:99], v[88:91]
v_and_b32 v236, s54, v155
v_sub_f32 v233, v233, v234
v_mfma_f32_16x16x32_bf16 v[92:95], v[168:171], a[96:99], v[92:95]
v_sub_f32 v235, v235, v236
v_cvt_pk_bf16_f32 v187, v233, v235
v_mfma_f32_16x16x32_bf16 v[92:95], v[172:175], a[100:103], v[92:95]
v_lshlrev_b32 v233, 16, v124
v_lshlrev_b32 v234, 16, v156
v_and_b32 v235, s54, v124
v_mfma_f32_16x16x32_bf16 v[64:67], v[176:179], a[76:79], v[64:67]
ds_read_b128 a[36:39], v224 offset:64
v_and_b32 v236, s54, v156
v_sub_f32 v233, v233, v234
v_mfma_f32_16x16x32_bf16 v[64:67], v[180:183], a[80:83], v[64:67]
v_sub_f32 v235, v235, v236
v_cvt_pk_bf16_f32 v188, v233, v235
v_mfma_f32_16x16x32_bf16 v[68:71], v[176:179], a[80:83], v[68:71]
v_lshlrev_b32 v233, 16, v125
v_lshlrev_b32 v234, 16, v157
v_mfma_f32_16x16x32_bf16 v[68:71], v[180:183], a[84:87], v[68:71]
ds_read_b128 a[40:43], v224 offset:128
v_and_b32 v235, s54, v125
v_and_b32 v236, s54, v157
v_mfma_f32_16x16x32_bf16 v[72:75], v[176:179], a[84:87], v[72:75]
v_sub_f32 v233, v233, v234
v_sub_f32 v235, v235, v236
v_mfma_f32_16x16x32_bf16 v[72:75], v[180:183], a[88:91], v[72:75]
v_cvt_pk_bf16_f32 v189, v233, v235
v_lshlrev_b32 v233, 16, v126
v_lshlrev_b32 v234, 16, v158
v_mfma_f32_16x16x32_bf16 v[76:79], v[176:179], a[88:91], v[76:79]
ds_read_b128 a[44:47], v224 offset:192
v_and_b32 v235, s54, v126
v_and_b32 v236, s54, v158
v_mfma_f32_16x16x32_bf16 v[76:79], v[180:183], a[92:95], v[76:79]
v_sub_f32 v233, v233, v234
v_sub_f32 v235, v235, v236
v_mfma_f32_16x16x32_bf16 v[80:83], v[176:179], a[92:95], v[80:83]
v_cvt_pk_bf16_f32 v190, v233, v235
v_lshlrev_b32 v233, 16, v127
v_mfma_f32_16x16x32_bf16 v[80:83], v[180:183], a[96:99], v[80:83]
v_lshlrev_b32 v234, 16, v159
v_and_b32 v235, s54, v127
v_mfma_f32_16x16x32_bf16 v[84:87], v[176:179], a[96:99], v[84:87]
ds_read_b128 a[48:51], v224 offset:256
v_and_b32 v236, s54, v159
v_sub_f32 v233, v233, v234
v_mfma_f32_16x16x32_bf16 v[84:87], v[180:183], a[100:103], v[84:87]
v_sub_f32 v235, v235, v236
v_cvt_pk_bf16_f32 v191, v233, v235
v_mfma_f32_16x16x32_bf16 v[88:91], v[176:179], a[100:103], v[88:91]
v_mfma_f32_16x16x32_bf16 v[88:91], v[180:183], a[104:107], v[88:91]
ds_read_b128 a[52:55], v224 offset:320
s_waitcnt vmcnt(14)
s_barrier
v_mfma_f32_16x16x32_bf16 v[92:95], v[176:179], a[104:107], v[92:95]
ds_read_b64_tr_b16 v[96:97], v238 offset:0
ds_read_b64_tr_b16 v[98:99], v238 offset:512
v_mfma_f32_16x16x32_bf16 v[92:95], v[180:183], a[108:111], v[92:95]
ds_read_b64_tr_b16 v[100:101], v238 offset:4096
v_mfma_f32_16x16x32_bf16 v[64:67], v[184:187], a[84:87], v[64:67]
ds_read_b128 a[56:59], v224 offset:384
ds_read_b64_tr_b16 v[102:103], v238 offset:4608
v_mfma_f32_16x16x32_bf16 v[64:67], v[188:191], a[88:91], v[64:67]
ds_read_b64_tr_b16 v[104:105], v238 offset:8192
v_mfma_f32_16x16x32_bf16 v[68:71], v[184:187], a[88:91], v[68:71]
ds_read_b64_tr_b16 v[106:107], v238 offset:8704
ds_read_b64_tr_b16 v[108:109], v238 offset:12288
v_mfma_f32_16x16x32_bf16 v[68:71], v[188:191], a[92:95], v[68:71]
ds_read_b64_tr_b16 v[110:111], v238 offset:12800
v_mfma_f32_16x16x32_bf16 v[72:75], v[184:187], a[92:95], v[72:75]
ds_read_b64_tr_b16 v[112:113], v238 offset:16384
v_mfma_f32_16x16x32_bf16 v[72:75], v[188:191], a[96:99], v[72:75]
ds_read_b64_tr_b16 v[114:115], v238 offset:16896
v_mfma_f32_16x16x32_bf16 v[76:79], v[184:187], a[96:99], v[76:79]
ds_read_b64_tr_b16 v[116:117], v238 offset:20480
ds_read_b64_tr_b16 v[118:119], v238 offset:20992
v_mfma_f32_16x16x32_bf16 v[76:79], v[188:191], a[100:103], v[76:79]
ds_read_b64_tr_b16 v[120:121], v238 offset:24576
v_mfma_f32_16x16x32_bf16 v[80:83], v[184:187], a[100:103], v[80:83]
ds_read_b64_tr_b16 v[122:123], v238 offset:25088
v_mfma_f32_16x16x32_bf16 v[80:83], v[188:191], a[104:107], v[80:83]
ds_read_b64_tr_b16 v[124:125], v238 offset:28672
v_mfma_f32_16x16x32_bf16 v[84:87], v[184:187], a[104:107], v[84:87]
ds_read_b64_tr_b16 v[126:127], v238 offset:29184
s_add_u32 s49, s49, 64
v_mfma_f32_16x16x32_bf16 v[84:87], v[188:191], a[108:111], v[84:87]
s_add_u32 s50, s50, 64
v_mfma_f32_16x16x32_bf16 v[88:91], v[184:187], a[108:111], v[88:91]
s_add_u32 s52, s52, 1
v_mfma_f32_16x16x32_bf16 v[88:91], v[188:191], a[112:115], v[88:91]
v_mfma_f32_16x16x32_bf16 v[92:95], v[184:187], a[112:115], v[92:95]
v_mfma_f32_16x16x32_bf16 v[92:95], v[188:191], a[116:119], v[92:95]
s_waitcnt lgkmcnt(0)
s_barrier
v_mfma_f32_16x16x32_bf16 v[0:3], v[96:99], a[0:3], v[0:3]
ds_read_b128 v[192:195], v205 offset:512
ds_read_b128 v[196:199], v206 offset:0
v_mfma_f32_16x16x32_bf16 v[0:3], v[100:103], a[4:7], v[0:3]
ds_read_b32 v230, v207 offset:512
v_mfma_f32_16x16x32_bf16 v[4:7], v[96:99], a[4:7], v[4:7]
ds_read_b128 a[60:63], v204 offset:512
ds_read_b32 v231, v207 offset:64
v_mfma_f32_16x16x32_bf16 v[4:7], v[100:103], a[8:11], v[4:7]
v_mfma_f32_16x16x32_bf16 v[8:11], v[96:99], a[8:11], v[8:11]
v_mfma_f32_16x16x32_bf16 v[8:11], v[100:103], a[12:15], v[8:11]
ds_read_b128 a[64:67], v204 offset:576
v_mfma_f32_16x16x32_bf16 v[12:15], v[96:99], a[12:15], v[12:15]
v_mfma_f32_16x16x32_bf16 v[12:15], v[100:103], a[16:19], v[12:15]
v_mfma_f32_16x16x32_bf16 v[16:19], v[96:99], a[16:19], v[16:19]
ds_read_b128 a[68:71], v204 offset:640
s_waitcnt lgkmcnt(5)
v_lshlrev_b32 v200, 16, v192
v_lshlrev_b32 v201, 16, v196
v_and_b32 v202, s54, v192
v_and_b32 v203, s54, v196
v_sub_f32 v200, v200, v201
v_sub_f32 v202, v202, v203
v_cvt_pk_bf16_f32 v192, v200, v202
v_lshlrev_b32 v200, 16, v193
v_mfma_f32_16x16x32_bf16 v[16:19], v[100:103], a[20:23], v[16:19]
v_lshlrev_b32 v201, 16, v197
v_mfma_f32_16x16x32_bf16 v[20:23], v[96:99], a[20:23], v[20:23]
v_and_b32 v202, s54, v193
v_and_b32 v203, s54, v197
v_mfma_f32_16x16x32_bf16 v[20:23], v[100:103], a[24:27], v[20:23]
v_sub_f32 v200, v200, v201
v_mfma_f32_16x16x32_bf16 v[24:27], v[96:99], a[24:27], v[24:27]
ds_read_b128 a[72:75], v204 offset:704
v_sub_f32 v202, v202, v203
v_cvt_pk_bf16_f32 v193, v200, v202
v_mfma_f32_16x16x32_bf16 v[24:27], v[100:103], a[28:31], v[24:27]
v_lshlrev_b32 v200, 16, v194
v_mfma_f32_16x16x32_bf16 v[28:31], v[96:99], a[28:31], v[28:31]
v_lshlrev_b32 v201, 16, v198
v_mfma_f32_16x16x32_bf16 v[28:31], v[100:103], a[32:35], v[28:31]
ds_read_b128 a[76:79], v204 offset:768
v_and_b32 v202, s54, v194
v_and_b32 v203, s54, v198
v_mfma_f32_16x16x32_bf16 v[0:3], v[104:107], a[8:11], v[0:3]
v_sub_f32 v200, v200, v201
v_mfma_f32_16x16x32_bf16 v[0:3], v[108:111], a[12:15], v[0:3]
v_sub_f32 v202, v202, v203
v_mfma_f32_16x16x32_bf16 v[4:7], v[104:107], a[12:15], v[4:7]
ds_read_b128 a[80:83], v204 offset:832
v_cvt_pk_bf16_f32 v194, v200, v202
v_lshlrev_b32 v200, 16, v195
v_mfma_f32_16x16x32_bf16 v[4:7], v[108:111], a[16:19], v[4:7]
v_lshlrev_b32 v201, 16, v199
v_mfma_f32_16x16x32_bf16 v[8:11], v[104:107], a[16:19], v[8:11]
v_and_b32 v202, s54, v195
v_and_b32 v203, s54, v199
v_mfma_f32_16x16x32_bf16 v[8:11], v[108:111], a[20:23], v[8:11]
v_sub_f32 v200, v200, v201
v_mfma_f32_16x16x32_bf16 v[12:15], v[104:107], a[20:23], v[12:15]
ds_read_b128 a[84:87], v204 offset:896
v_sub_f32 v202, v202, v203
v_mfma_f32_16x16x32_bf16 v[12:15], v[108:111], a[24:27], v[12:15]
v_cvt_pk_bf16_f32 v195, v200, v202
ds_write_b128 v205, v[192:195] offset:1024
v_mfma_f32_16x16x32_bf16 v[16:19], v[104:107], a[24:27], v[16:19]
s_waitcnt lgkmcnt(7)
v_mfma_f32_16x16x32_bf16 v[16:19], v[108:111], a[28:31], v[16:19]
ds_read_b128 a[88:91], v204 offset:960
v_lshlrev_b32 v200, 16, v230
v_lshlrev_b32 v201, 16, v231
v_mfma_f32_16x16x32_bf16 v[20:23], v[104:107], a[28:31], v[20:23]
v_and_b32 v202, s54, v230
v_mfma_f32_16x16x32_bf16 v[20:23], v[108:111], a[32:35], v[20:23]
v_and_b32 v203, s54, v231
v_mfma_f32_16x16x32_bf16 v[24:27], v[104:107], a[32:35], v[24:27]
s_waitcnt vmcnt(6)
s_barrier
ds_read_b128 a[92:95], v224 offset:512
v_sub_f32 v200, v200, v201
v_sub_f32 v202, v202, v203
v_mfma_f32_16x16x32_bf16 v[24:27], v[108:111], a[36:39], v[24:27]
v_cvt_pk_bf16_f32 v230, v200, v202
v_mfma_f32_16x16x32_bf16 v[28:31], v[104:107], a[36:39], v[28:31]
ds_read_b64_tr_b16 v[128:129], v238 offset:32768
ds_write_b32 v207, v230 offset:1024
ds_read_b128 v[192:195], v205 offset:3712
v_mfma_f32_16x16x32_bf16 v[28:31], v[108:111], a[40:43], v[28:31]
ds_read_b64_tr_b16 v[130:131], v238 offset:33280
ds_read_b128 v[196:199], v225 offset:3200
v_mfma_f32_16x16x32_bf16 v[0:3], v[112:115], a[16:19], v[0:3]
ds_read_b128 a[96:99], v224 offset:576
v_mfma_f32_16x16x32_bf16 v[0:3], v[116:119], a[20:23], v[0:3]
ds_read_b64_tr_b16 v[132:133], v238 offset:36864
v_mfma_f32_16x16x32_bf16 v[4:7], v[112:115], a[20:23], v[4:7]
ds_read_b64_tr_b16 v[134:135], v238 offset:37376
v_mfma_f32_16x16x32_bf16 v[4:7], v[116:119], a[24:27], v[4:7]
ds_read_b128 a[100:103], v224 offset:640
v_mfma_f32_16x16x32_bf16 v[8:11], v[112:115], a[24:27], v[8:11]
ds_read_b64_tr_b16 v[136:137], v238 offset:40960
v_mfma_f32_16x16x32_bf16 v[8:11], v[116:119], a[28:31], v[8:11]
ds_read_b64_tr_b16 v[138:139], v238 offset:41472
s_waitcnt lgkmcnt(6)
v_lshlrev_b32 v200, 16, v192
v_lshlrev_b32 v201, 16, v196
v_and_b32 v202, s54, v192
v_and_b32 v203, s54, v196
v_sub_f32 v200, v200, v201
v_sub_f32 v202, v202, v203
v_cvt_pk_bf16_f32 v192, v200, v202
v_mfma_f32_16x16x32_bf16 v[12:15], v[112:115], a[28:31], v[12:15]
ds_read_b128 a[104:107], v224 offset:704
v_lshlrev_b32 v200, 16, v193
v_lshlrev_b32 v201, 16, v197
v_mfma_f32_16x16x32_bf16 v[12:15], v[116:119], a[32:35], v[12:15]
ds_read_b64_tr_b16 v[140:141], v238 offset:45056
v_and_b32 v202, s54, v193
v_mfma_f32_16x16x32_bf16 v[16:19], v[112:115], a[32:35], v[16:19]
ds_read_b64_tr_b16 v[142:143], v238 offset:45568
v_and_b32 v203, s54, v197
v_mfma_f32_16x16x32_bf16 v[16:19], v[116:119], a[36:39], v[16:19]
v_sub_f32 v200, v200, v201
v_sub_f32 v202, v202, v203
v_mfma_f32_16x16x32_bf16 v[20:23], v[112:115], a[36:39], v[20:23]
ds_read_b64_tr_b16 v[144:145], v238 offset:49152
ds_read_b128 a[108:111], v224 offset:768
v_cvt_pk_bf16_f32 v193, v200, v202
v_mfma_f32_16x16x32_bf16 v[20:23], v[116:119], a[40:43], v[20:23]
ds_read_b64_tr_b16 v[146:147], v238 offset:49664
v_lshlrev_b32 v200, 16, v194
v_lshlrev_b32 v201, 16, v198
v_mfma_f32_16x16x32_bf16 v[24:27], v[112:115], a[40:43], v[24:27]
v_and_b32 v202, s54, v194
v_mfma_f32_16x16x32_bf16 v[24:27], v[116:119], a[44:47], v[24:27]
ds_read_b64_tr_b16 v[148:149], v238 offset:53248
ds_read_b128 a[112:115], v224 offset:832
v_and_b32 v203, s54, v198
v_mfma_f32_16x16x32_bf16 v[28:31], v[112:115], a[44:47], v[28:31]
ds_read_b64_tr_b16 v[150:151], v238 offset:53760
v_sub_f32 v200, v200, v201
v_sub_f32 v202, v202, v203
v_mfma_f32_16x16x32_bf16 v[28:31], v[116:119], a[48:51], v[28:31]
v_cvt_pk_bf16_f32 v194, v200, v202
v_mfma_f32_16x16x32_bf16 v[0:3], v[120:123], a[24:27], v[0:3]
ds_read_b64_tr_b16 v[152:153], v238 offset:57344
ds_read_b128 a[116:119], v224 offset:896
v_lshlrev_b32 v200, 16, v195
v_lshlrev_b32 v201, 16, v199
v_mfma_f32_16x16x32_bf16 v[0:3], v[124:127], a[28:31], v[0:3]
ds_read_b64_tr_b16 v[154:155], v238 offset:57856
v_and_b32 v202, s54, v195
v_mfma_f32_16x16x32_bf16 v[4:7], v[120:123], a[28:31], v[4:7]
v_and_b32 v203, s54, v199
v_mfma_f32_16x16x32_bf16 v[4:7], v[124:127], a[32:35], v[4:7]
ds_read_b64_tr_b16 v[156:157], v238 offset:61440
v_sub_f32 v200, v200, v201
v_sub_f32 v202, v202, v203
v_mfma_f32_16x16x32_bf16 v[8:11], v[120:123], a[32:35], v[8:11]
ds_read_b64_tr_b16 v[158:159], v238 offset:61952
v_cvt_pk_bf16_f32 v195, v200, v202
v_mfma_f32_16x16x32_bf16 v[8:11], v[124:127], a[36:39], v[8:11]
ds_write_b128 v205, v[192:195] offset:4224
v_mfma_f32_16x16x32_bf16 v[12:15], v[120:123], a[36:39], v[12:15]
v_mfma_f32_16x16x32_bf16 v[12:15], v[124:127], a[40:43], v[12:15]
v_mfma_f32_16x16x32_bf16 v[16:19], v[120:123], a[40:43], v[16:19]
v_mfma_f32_16x16x32_bf16 v[16:19], v[124:127], a[44:47], v[16:19]
v_mfma_f32_16x16x32_bf16 v[20:23], v[120:123], a[44:47], v[20:23]
v_mfma_f32_16x16x32_bf16 v[20:23], v[124:127], a[48:51], v[20:23]
v_mfma_f32_16x16x32_bf16 v[24:27], v[120:123], a[48:51], v[24:27]
v_mfma_f32_16x16x32_bf16 v[24:27], v[124:127], a[52:55], v[24:27]
v_mfma_f32_16x16x32_bf16 v[28:31], v[120:123], a[52:55], v[28:31]
v_mfma_f32_16x16x32_bf16 v[28:31], v[124:127], a[56:59], v[28:31]
s_waitcnt lgkmcnt(0)
s_waitcnt vmcnt(1)
s_barrier
v_mfma_f32_16x16x32_bf16 v[32:35], v[128:131], a[60:63], v[32:35]
s_mov_b32 s64, s8
v_lshlrev_b32 v233, 16, v96
v_lshlrev_b32 v234, 16, v128
v_and_b32 v235, s54, v96
v_mfma_f32_16x16x32_bf16 v[32:35], v[132:135], a[64:67], v[32:35]
buffer_load_dwordx2 v[216:217], v219, s[36:39], s91 offen sc1
v_mfma_f32_16x16x32_bf16 v[36:39], v[128:131], a[64:67], v[36:39]
s_mov_b32 s65, s9
s_mov_b32 s66, 512
ds_read_b128 a[0:3], v204 offset:1024
v_and_b32 v236, s54, v128
v_sub_f32 v233, v233, v234
v_sub_f32 v235, v235, v236
v_cvt_pk_bf16_f32 v160, v233, v235
v_lshlrev_b32 v233, 16, v97
v_lshlrev_b32 v234, 16, v129
v_mfma_f32_16x16x32_bf16 v[36:39], v[132:135], a[68:71], v[36:39]
s_add_u32 m0, s53, 0
s_mov_b32 s67, 0x00020000
v_and_b32 v235, s54, v97
v_and_b32 v236, s54, v129
v_mfma_f32_16x16x32_bf16 v[40:43], v[128:131], a[68:71], v[40:43]
buffer_load_dwordx4 v208, s[20:23], s49 offen lds
v_mfma_f32_16x16x32_bf16 v[40:43], v[132:135], a[72:75], v[40:43]
s_mov_b32 s68, s10
s_mov_b32 s69, s11
ds_read_b128 a[4:7], v204 offset:1088
v_sub_f32 v233, v233, v234
v_sub_f32 v235, v235, v236
v_cvt_pk_bf16_f32 v161, v233, v235
v_lshlrev_b32 v233, 16, v98
v_lshlrev_b32 v234, 16, v130
v_and_b32 v235, s54, v98
v_mfma_f32_16x16x32_bf16 v[44:47], v[128:131], a[72:75], v[44:47]
s_add_u32 m0, s53, 6400
s_mov_b32 s70, 512
v_and_b32 v236, s54, v130
v_sub_f32 v233, v233, v234
v_mfma_f32_16x16x32_bf16 v[44:47], v[132:135], a[76:79], v[44:47]
buffer_load_dwordx4 v209, s[20:23], s49 offen lds
v_mfma_f32_16x16x32_bf16 v[48:51], v[128:131], a[76:79], v[48:51]
s_mov_b32 s71, 0x00020000
s_lshl_b32 s56, s46, 7
ds_read_b128 a[8:11], v204 offset:1152
v_sub_f32 v235, v235, v236
v_cvt_pk_bf16_f32 v162, v233, v235
v_lshlrev_b32 v233, 16, v99
v_lshlrev_b32 v234, 16, v131
v_and_b32 v235, s54, v99
v_and_b32 v236, s54, v131
v_mfma_f32_16x16x32_bf16 v[48:51], v[132:135], a[80:83], v[48:51]
s_add_u32 m0, s53, 12800
s_lshl_b32 s57, s44, 5
v_sub_f32 v233, v233, v234
v_sub_f32 v235, v235, v236
v_cvt_pk_bf16_f32 v163, v233, v235
v_mfma_f32_16x16x32_bf16 v[52:55], v[128:131], a[80:83], v[52:55]
buffer_load_dwordx4 v210, s[20:23], s49 offen lds
v_mfma_f32_16x16x32_bf16 v[52:55], v[132:135], a[84:87], v[52:55]
s_add_u32 s57, s56, s57
v_bfe_u32 v221, v232, 4, 2
v_lshlrev_b32 v233, 16, v100
v_lshlrev_b32 v234, 16, v132
v_and_b32 v235, s54, v100
v_and_b32 v236, s54, v132
v_sub_f32 v233, v233, v234
v_mfma_f32_16x16x32_bf16 v[56:59], v[128:131], a[84:87], v[56:59]
s_add_u32 m0, s53, 19200
v_lshlrev_b32 v221, 3, v221
ds_read_b128 a[12:15], v204 offset:1216
v_sub_f32 v235, v235, v236
v_cvt_pk_bf16_f32 v164, v233, v235
v_lshlrev_b32 v233, 16, v101
v_mfma_f32_16x16x32_bf16 v[56:59], v[132:135], a[88:91], v[56:59]
buffer_load_dwordx4 v211, s[20:23], s49 offen lds
v_mfma_f32_16x16x32_bf16 v[60:63], v[128:131], a[88:91], v[60:63]
s_mul_i32 s58, s47, 4088320
s_mov_b32 s30, 4088320
v_lshlrev_b32 v234, 16, v133
v_and_b32 v235, s54, v101
v_and_b32 v236, s54, v133
v_sub_f32 v233, v233, v234
v_sub_f32 v235, v235, v236
v_mfma_f32_16x16x32_bf16 v[60:63], v[132:135], a[92:95], v[60:63]
s_add_u32 m0, s55, 0
s_mov_b32 s31, 0x00020000
ds_read_b128 a[16:19], v204 offset:1280
v_cvt_pk_bf16_f32 v165, v233, v235
v_lshlrev_b32 v233, 16, v102
v_lshlrev_b32 v234, 16, v134
v_mfma_f32_16x16x32_bf16 v[32:35], v[136:139], a[68:71], v[32:35]
buffer_load_dword v212, s[20:23], s49 offen lds
v_mfma_f32_16x16x32_bf16 v[32:35], v[140:143], a[72:75], v[32:35]
v_and_b32 v235, s54, v102
v_and_b32 v236, s54, v134
v_sub_f32 v233, v233, v234
v_sub_f32 v235, v235, v236
v_cvt_pk_bf16_f32 v166, v233, v235
v_mfma_f32_16x16x32_bf16 v[36:39], v[136:139], a[72:75], v[36:39]
s_add_u32 s28, s12, s58
s_addc_u32 s29, s13, 0
ds_read_b128 a[20:23], v204 offset:1344
v_lshlrev_b32 v233, 16, v103
v_lshlrev_b32 v234, 16, v135
v_and_b32 v235, s54, v103
v_mfma_f32_16x16x32_bf16 v[36:39], v[140:143], a[76:79], v[36:39]
buffer_load_dwordx2 a[120:121], v221, s[64:67], s57 offen
v_mfma_f32_16x16x32_bf16 v[40:43], v[136:139], a[76:79], v[40:43]
v_and_b32 v236, s54, v135
v_sub_f32 v233, v233, v234
v_sub_f32 v235, v235, v236
v_cvt_pk_bf16_f32 v167, v233, v235
v_lshlrev_b32 v233, 16, v104
v_mfma_f32_16x16x32_bf16 v[40:43], v[140:143], a[80:83], v[40:43]
buffer_load_dwordx2 a[122:123], v221, s[68:71], s57 offen
v_mfma_f32_16x16x32_bf16 v[44:47], v[136:139], a[80:83], v[44:47]
ds_read_b128 a[24:27], v204 offset:1408
v_lshlrev_b32 v234, 16, v136
v_and_b32 v235, s54, v104
v_and_b32 v236, s54, v136
v_sub_f32 v233, v233, v234
v_sub_f32 v235, v235, v236
v_cvt_pk_bf16_f32 v168, v233, v235
v_mfma_f32_16x16x32_bf16 v[44:47], v[140:143], a[84:87], v[44:47]
v_lshlrev_b32 v233, 16, v105
v_lshlrev_b32 v234, 16, v137
v_and_b32 v235, s54, v105
v_mfma_f32_16x16x32_bf16 v[48:51], v[136:139], a[84:87], v[48:51]
v_and_b32 v236, s54, v137
v_sub_f32 v233, v233, v234
v_mfma_f32_16x16x32_bf16 v[48:51], v[140:143], a[88:91], v[48:51]
ds_read_b128 a[28:31], v204 offset:1472
v_sub_f32 v235, v235, v236
v_cvt_pk_bf16_f32 v169, v233, v235
v_lshlrev_b32 v233, 16, v106
v_mfma_f32_16x16x32_bf16 v[52:55], v[136:139], a[88:91], v[52:55]
v_lshlrev_b32 v234, 16, v138
v_and_b32 v235, s54, v106
v_and_b32 v236, s54, v138
v_mfma_f32_16x16x32_bf16 v[52:55], v[140:143], a[92:95], v[52:55]
v_sub_f32 v233, v233, v234
v_sub_f32 v235, v235, v236
v_mfma_f32_16x16x32_bf16 v[56:59], v[136:139], a[92:95], v[56:59]
ds_read_b128 a[32:35], v224 offset:1024
v_cvt_pk_bf16_f32 v170, v233, v235
v_lshlrev_b32 v233, 16, v107
v_lshlrev_b32 v234, 16, v139
v_mfma_f32_16x16x32_bf16 v[56:59], v[140:143], a[96:99], v[56:59]
v_and_b32 v235, s54, v107
v_and_b32 v236, s54, v139
v_sub_f32 v233, v233, v234
v_mfma_f32_16x16x32_bf16 v[60:63], v[136:139], a[96:99], v[60:63]
v_sub_f32 v235, v235, v236
v_cvt_pk_bf16_f32 v171, v233, v235
v_mfma_f32_16x16x32_bf16 v[60:63], v[140:143], a[100:103], v[60:63]
v_lshlrev_b32 v233, 16, v108
v_lshlrev_b32 v234, 16, v140
v_and_b32 v235, s54, v108
v_mfma_f32_16x16x32_bf16 v[32:35], v[144:147], a[76:79], v[32:35]
ds_read_b128 a[36:39], v224 offset:1088
v_and_b32 v236, s54, v140
v_sub_f32 v233, v233, v234
v_sub_f32 v235, v235, v236
v_mfma_f32_16x16x32_bf16 v[32:35], v[148:151], a[80:83], v[32:35]
v_cvt_pk_bf16_f32 v172, v233, v235
v_lshlrev_b32 v233, 16, v109
v_lshlrev_b32 v234, 16, v141
v_mfma_f32_16x16x32_bf16 v[36:39], v[144:147], a[80:83], v[36:39]
v_and_b32 v235, s54, v109
v_and_b32 v236, s54, v141
v_mfma_f32_16x16x32_bf16 v[36:39], v[148:151], a[84:87], v[36:39]
ds_read_b128 a[40:43], v224 offset:1152
v_sub_f32 v233, v233, v234
v_sub_f32 v235, v235, v236
v_cvt_pk_bf16_f32 v173, v233, v235
v_mfma_f32_16x16x32_bf16 v[40:43], v[144:147], a[84:87], v[40:43]
v_lshlrev_b32 v233, 16, v110
v_lshlrev_b32 v234, 16, v142
v_and_b32 v235, s54, v110
v_mfma_f32_16x16x32_bf16 v[40:43], v[148:151], a[88:91], v[40:43]
v_and_b32 v236, s54, v142
v_sub_f32 v233, v233, v234
v_mfma_f32_16x16x32_bf16 v[44:47], v[144:147], a[88:91], v[44:47]
ds_read_b128 a[44:47], v224 offset:1216
v_sub_f32 v235, v235, v236
v_cvt_pk_bf16_f32 v174, v233, v235
v_lshlrev_b32 v233, 16, v111
v_mfma_f32_16x16x32_bf16 v[44:47], v[148:151], a[92:95], v[44:47]
v_lshlrev_b32 v234, 16, v143
v_and_b32 v235, s54, v111
v_and_b32 v236, s54, v143
v_mfma_f32_16x16x32_bf16 v[48:51], v[144:147], a[92:95], v[48:51]
v_sub_f32 v233, v233, v234
v_sub_f32 v235, v235, v236
v_cvt_pk_bf16_f32 v175, v233, v235
v_mfma_f32_16x16x32_bf16 v[48:51], v[148:151], a[96:99], v[48:51]
v_lshlrev_b32 v233, 16, v112
v_lshlrev_b32 v234, 16, v144
v_mfma_f32_16x16x32_bf16 v[52:55], v[144:147], a[96:99], v[52:55]
ds_read_b128 a[48:51], v224 offset:1280
v_and_b32 v235, s54, v112
v_and_b32 v236, s54, v144
v_sub_f32 v233, v233, v234
v_mfma_f32_16x16x32_bf16 v[52:55], v[148:151], a[100:103], v[52:55]
v_sub_f32 v235, v235, v236
v_cvt_pk_bf16_f32 v176, v233, v235
v_lshlrev_b32 v233, 16, v113
v_mfma_f32_16x16x32_bf16 v[56:59], v[144:147], a[100:103], v[56:59]
v_lshlrev_b32 v234, 16, v145
v_and_b32 v235, s54, v113
v_mfma_f32_16x16x32_bf16 v[56:59], v[148:151], a[104:107], v[56:59]
ds_read_b128 a[52:55], v224 offset:1344
v_and_b32 v236, s54, v145
v_sub_f32 v233, v233, v234
v_sub_f32 v235, v235, v236
v_mfma_f32_16x16x32_bf16 v[60:63], v[144:147], a[104:107], v[60:63]
v_cvt_pk_bf16_f32 v177, v233, v235
v_lshlrev_b32 v233, 16, v114
v_lshlrev_b32 v234, 16, v146
v_mfma_f32_16x16x32_bf16 v[60:63], v[148:151], a[108:111], v[60:63]
v_and_b32 v235, s54, v114
v_and_b32 v236, s54, v146
v_sub_f32 v233, v233, v234
v_mfma_f32_16x16x32_bf16 v[32:35], v[152:155], a[84:87], v[32:35]
ds_read_b128 a[56:59], v224 offset:1408
v_sub_f32 v235, v235, v236
v_cvt_pk_bf16_f32 v178, v233, v235
v_mfma_f32_16x16x32_bf16 v[32:35], v[156:159], a[88:91], v[32:35]
v_lshlrev_b32 v233, 16, v115
v_lshlrev_b32 v234, 16, v147
v_and_b32 v235, s54, v115
v_mfma_f32_16x16x32_bf16 v[36:39], v[152:155], a[88:91], v[36:39]
v_and_b32 v236, s54, v147
v_sub_f32 v233, v233, v234
v_sub_f32 v235, v235, v236
v_mfma_f32_16x16x32_bf16 v[36:39], v[156:159], a[92:95], v[36:39]
v_cvt_pk_bf16_f32 v179, v233, v235
v_lshlrev_b32 v233, 16, v116
v_mfma_f32_16x16x32_bf16 v[40:43], v[152:155], a[92:95], v[40:43]
v_lshlrev_b32 v234, 16, v148
v_and_b32 v235, s54, v116
v_and_b32 v236, s54, v148
v_mfma_f32_16x16x32_bf16 v[40:43], v[156:159], a[96:99], v[40:43]
v_sub_f32 v233, v233, v234
v_sub_f32 v235, v235, v236
v_cvt_pk_bf16_f32 v180, v233, v235
v_mfma_f32_16x16x32_bf16 v[44:47], v[152:155], a[96:99], v[44:47]
v_lshlrev_b32 v233, 16, v117
v_lshlrev_b32 v234, 16, v149
v_and_b32 v235, s54, v117
v_mfma_f32_16x16x32_bf16 v[44:47], v[156:159], a[100:103], v[44:47]
v_and_b32 v236, s54, v149
v_sub_f32 v233, v233, v234
v_mfma_f32_16x16x32_bf16 v[48:51], v[152:155], a[100:103], v[48:51]
v_sub_f32 v235, v235, v236
v_cvt_pk_bf16_f32 v181, v233, v235
v_lshlrev_b32 v233, 16, v118
v_mfma_f32_16x16x32_bf16 v[48:51], v[156:159], a[104:107], v[48:51]
v_lshlrev_b32 v234, 16, v150
v_and_b32 v235, s54, v118
v_and_b32 v236, s54, v150
v_mfma_f32_16x16x32_bf16 v[52:55], v[152:155], a[104:107], v[52:55]
v_sub_f32 v233, v233, v234
v_sub_f32 v235, v235, v236
v_mfma_f32_16x16x32_bf16 v[52:55], v[156:159], a[108:111], v[52:55]
v_cvt_pk_bf16_f32 v182, v233, v235
v_lshlrev_b32 v233, 16, v119
v_lshlrev_b32 v234, 16, v151
v_mfma_f32_16x16x32_bf16 v[56:59], v[152:155], a[108:111], v[56:59]
v_and_b32 v235, s54, v119
v_and_b32 v236, s54, v151
v_sub_f32 v233, v233, v234
v_mfma_f32_16x16x32_bf16 v[56:59], v[156:159], a[112:115], v[56:59]
v_sub_f32 v235, v235, v236
v_cvt_pk_bf16_f32 v183, v233, v235
v_mfma_f32_16x16x32_bf16 v[60:63], v[152:155], a[112:115], v[60:63]
v_mfma_f32_16x16x32_bf16 v[60:63], v[156:159], a[116:119], v[60:63]
s_waitcnt lgkmcnt(0)
s_cmp_lg_u32 s44, 0
s_cbranch_scc1 LM_fok
s_waitcnt vmcnt(7)
LM_fchk:
v_cmp_ne_u64 vcc, v[214:215], v[216:217]
s_add_u32 s90, s90, 1
s_cmp_ge_u32 s90, 4000000
s_cbranch_scc1 LM_fok
s_cbranch_vccz LM_fok
s_sleep 2
buffer_load_dwordx2 v[216:217], v219, s[36:39], s87 offen sc1
s_waitcnt vmcnt(0)
s_branch LM_fchk
LM_fok:
s_barrier
v_mfma_f32_16x16x32_bf16 v[64:67], v[160:163], a[0:3], v[64:67]
v_lshlrev_b32 v233, 16, v120
v_lshlrev_b32 v234, 16, v152
v_and_b32 v235, s54, v120
ds_read_b128 v[192:195], v205 offset:27712
v_mfma_f32_16x16x32_bf16 v[64:67], v[164:167], a[4:7], v[64:67]
v_and_b32 v236, s54, v152
v_sub_f32 v233, v233, v234
v_sub_f32 v235, v235, v236
ds_read_b128 v[196:199], v206 offset:27200
v_mfma_f32_16x16x32_bf16 v[68:71], v[160:163], a[4:7], v[68:71]
v_cvt_pk_bf16_f32 v184, v233, v235
v_lshlrev_b32 v233, 16, v121
v_lshlrev_b32 v234, 16, v153
ds_read_b128 a[60:63], v204 offset:27200
ds_read_b32 v230, v207 offset:27712
v_mfma_f32_16x16x32_bf16 v[68:71], v[164:167], a[8:11], v[68:71]
v_and_b32 v235, s54, v121
v_and_b32 v236, s54, v153
v_sub_f32 v233, v233, v234
ds_read_b32 v231, v207 offset:27264
v_mfma_f32_16x16x32_bf16 v[72:75], v[160:163], a[8:11], v[72:75]
buffer_load_dwordx4 v[96:99], v213, s[24:27], s51 offen offset:0 sc1
v_mfma_f32_16x16x32_bf16 v[72:75], v[164:167], a[12:15], v[72:75]
v_sub_f32 v235, v235, v236
v_cvt_pk_bf16_f32 v185, v233, v235
v_lshlrev_b32 v233, 16, v122
v_lshlrev_b32 v234, 16, v154
v_and_b32 v235, s54, v122
v_and_b32 v236, s54, v154
ds_read_b128 a[64:67], v204 offset:27264
v_mfma_f32_16x16x32_bf16 v[76:79], v[160:163], a[12:15], v[76:79]
v_sub_f32 v233, v233, v234
v_sub_f32 v235, v235, v236
v_cvt_pk_bf16_f32 v186, v233, v235
v_mfma_f32_16x16x32_bf16 v[76:79], v[164:167], a[16:19], v[76:79]
buffer_load_dwordx4 v[100:103], v213, s[24:27], s51 offen offset:1024 sc1
v_mfma_f32_16x16x32_bf16 v[80:83], v[160:163], a[16:19], v[80:83]
v_lshlrev_b32 v233, 16, v123
v_lshlrev_b32 v234, 16, v155
v_and_b32 v235, s54, v123
v_and_b32 v236, s54, v155
v_sub_f32 v233, v233, v234
v_sub_f32 v235, v235, v236
ds_read_b128 a[68:71], v204 offset:27328
v_mfma_f32_16x16x32_bf16 v[80:83], v[164:167], a[20:23], v[80:83]
v_cvt_pk_bf16_f32 v187, v233, v235
v_lshlrev_b32 v233, 16, v124
v_lshlrev_b32 v234, 16, v156
s_waitcnt lgkmcnt(5)
v_lshlrev_b32 v200, 16, v192
v_lshlrev_b32 v201, 16, v196
v_and_b32 v202, s54, v192
v_mfma_f32_16x16x32_bf16 v[84:87], v[160:163], a[20:23], v[84:87]
buffer_load_dwordx4 v[104:107], v213, s[24:27], s51 offen offset:2048 sc1
v_mfma_f32_16x16x32_bf16 v[84:87], v[164:167], a[24:27], v[84:87]
v_and_b32 v235, s54, v124
v_and_b32 v236, s54, v156
v_sub_f32 v233, v233, v234
v_sub_f32 v235, v235, v236
v_cvt_pk_bf16_f32 v188, v233, v235
v_lshlrev_b32 v233, 16, v125
v_and_b32 v203, s54, v196
v_sub_f32 v200, v200, v201
v_mfma_f32_16x16x32_bf16 v[88:91], v[160:163], a[24:27], v[88:91]
v_lshlrev_b32 v234, 16, v157
v_and_b32 v235, s54, v125
v_and_b32 v236, s54, v157
ds_read_b128 a[72:75], v204 offset:27392
v_sub_f32 v202, v202, v203
v_mfma_f32_16x16x32_bf16 v[88:91], v[164:167], a[28:31], v[88:91]
buffer_load_dwordx4 v[108:111], v213, s[24:27], s51 offen offset:3072 sc1
v_mfma_f32_16x16x32_bf16 v[92:95], v[160:163], a[28:31], v[92:95]
v_sub_f32 v233, v233, v234
v_sub_f32 v235, v235, v236
v_cvt_pk_bf16_f32 v189, v233, v235
v_lshlrev_b32 v233, 16, v126
v_lshlrev_b32 v234, 16, v158
v_and_b32 v235, s54, v126
v_cvt_pk_bf16_f32 v192, v200, v202
v_mfma_f32_16x16x32_bf16 v[92:95], v[164:167], a[32:35], v[92:95]
s_add_u32 s51, s51, 4096
v_and_b32 v236, s54, v158
v_sub_f32 v233, v233, v234
v_sub_f32 v235, v235, v236
ds_read_b128 a[76:79], v204 offset:27456
v_lshlrev_b32 v200, 16, v193
v_mfma_f32_16x16x32_bf16 v[64:67], v[168:171], a[8:11], v[64:67]
buffer_load_dwordx4 v[112:115], v213, s[24:27], s51 offen offset:0 sc1
v_mfma_f32_16x16x32_bf16 v[64:67], v[172:175], a[12:15], v[64:67]
v_cvt_pk_bf16_f32 v190, v233, v235
v_lshlrev_b32 v233, 16, v127
v_lshlrev_b32 v234, 16, v159
v_and_b32 v235, s54, v127
v_and_b32 v236, s54, v159
v_sub_f32 v233, v233, v234
v_lshlrev_b32 v201, 16, v197
v_and_b32 v202, s54, v193
v_mfma_f32_16x16x32_bf16 v[68:71], v[168:171], a[12:15], v[68:71]
v_sub_f32 v235, v235, v236
v_cvt_pk_bf16_f32 v191, v233, v235
ds_read_b128 a[80:83], v204 offset:27520
v_and_b32 v203, s54, v197
v_mfma_f32_16x16x32_bf16 v[68:71], v[172:175], a[16:19], v[68:71]
buffer_load_dwordx4 v[116:119], v213, s[24:27], s51 offen offset:1024 sc1
v_mfma_f32_16x16x32_bf16 v[72:75], v[168:171], a[16:19], v[72:75]
v_sub_f32 v200, v200, v201
v_mfma_f32_16x16x32_bf16 v[72:75], v[172:175], a[20:23], v[72:75]
v_sub_f32 v202, v202, v203
v_mfma_f32_16x16x32_bf16 v[76:79], v[168:171], a[20:23], v[76:79]
buffer_load_dwordx4 v[120:123], v213, s[24:27], s51 offen offset:2048 sc1
v_mfma_f32_16x16x32_bf16 v[76:79], v[172:175], a[24:27], v[76:79]
ds_read_b128 a[84:87], v204 offset:27584
v_cvt_pk_bf16_f32 v193, v200, v202
v_lshlrev_b32 v200, 16, v194
v_mfma_f32_16x16x32_bf16 v[80:83], v[168:171], a[24:27], v[80:83]
v_mfma_f32_16x16x32_bf16 v[80:83], v[172:175], a[28:31], v[80:83]
buffer_load_dwordx4 v[124:127], v213, s[24:27], s51 offen offset:3072 sc1
v_mfma_f32_16x16x32_bf16 v[84:87], v[168:171], a[28:31], v[84:87]
ds_read_b128 a[88:91], v204 offset:27648
v_lshlrev_b32 v201, 16, v198
v_and_b32 v202, s54, v194
v_mfma_f32_16x16x32_bf16 v[84:87], v[172:175], a[32:35], v[84:87]
s_add_u32 s51, s51, 4096
v_and_b32 v203, s54, v198
v_mfma_f32_16x16x32_bf16 v[88:91], v[168:171], a[32:35], v[88:91]
buffer_load_dwordx4 v[128:131], v213, s[24:27], s51 offen offset:0 sc1
v_mfma_f32_16x16x32_bf16 v[88:91], v[172:175], a[36:39], v[88:91]
ds_read_b128 a[92:95], v224 offset:27200
v_sub_f32 v200, v200, v201
v_mfma_f32_16x16x32_bf16 v[92:95], v[168:171], a[36:39], v[92:95]
v_sub_f32 v202, v202, v203
v_mfma_f32_16x16x32_bf16 v[92:95], v[172:175], a[40:43], v[92:95]
buffer_load_dwordx4 v[132:135], v213, s[24:27], s51 offen offset:1024 sc1
v_mfma_f32_16x16x32_bf16 v[64:67], v[176:179], a[16:19], v[64:67]
ds_read_b128 a[96:99], v224 offset:27264
v_cvt_pk_bf16_f32 v194, v200, v202
v_lshlrev_b32 v200, 16, v195
v_mfma_f32_16x16x32_bf16 v[64:67], v[180:183], a[20:23], v[64:67]
v_lshlrev_b32 v201, 16, v199
v_mfma_f32_16x16x32_bf16 v[68:71], v[176:179], a[20:23], v[68:71]
buffer_load_dwordx4 v[136:139], v213, s[24:27], s51 offen offset:2048 sc1
v_mfma_f32_16x16x32_bf16 v[68:71], v[180:183], a[24:27], v[68:71]
ds_read_b128 a[100:103], v224 offset:27328
v_and_b32 v202, s54, v195
v_mfma_f32_16x16x32_bf16 v[72:75], v[176:179], a[24:27], v[72:75]
v_and_b32 v203, s54, v199
v_mfma_f32_16x16x32_bf16 v[72:75], v[180:183], a[28:31], v[72:75]
buffer_load_dwordx4 v[140:143], v213, s[24:27], s51 offen offset:3072 sc1
v_mfma_f32_16x16x32_bf16 v[76:79], v[176:179], a[28:31], v[76:79]
ds_read_b128 a[104:107], v224 offset:27392
v_sub_f32 v200, v200, v201
v_sub_f32 v202, v202, v203
v_mfma_f32_16x16x32_bf16 v[76:79], v[180:183], a[32:35], v[76:79]
s_add_u32 s51, s51, 4096
v_mfma_f32_16x16x32_bf16 v[80:83], v[176:179], a[32:35], v[80:83]
buffer_load_dwordx4 v[144:147], v213, s[24:27], s51 offen offset:0 sc1
v_mfma_f32_16x16x32_bf16 v[80:83], v[180:183], a[36:39], v[80:83]
v_cvt_pk_bf16_f32 v195, v200, v202
ds_write_b128 v205, v[192:195] offset:28224
v_mfma_f32_16x16x32_bf16 v[84:87], v[176:179], a[36:39], v[84:87]
ds_read_b128 a[108:111], v224 offset:27456
s_waitcnt lgkmcnt(13)
v_mfma_f32_16x16x32_bf16 v[84:87], v[180:183], a[40:43], v[84:87]
buffer_load_dwordx4 v[148:151], v213, s[24:27], s51 offen offset:1024 sc1
v_mfma_f32_16x16x32_bf16 v[88:91], v[176:179], a[40:43], v[88:91]
v_lshlrev_b32 v200, 16, v230
v_mfma_f32_16x16x32_bf16 v[88:91], v[180:183], a[44:47], v[88:91]
ds_read_b128 a[112:115], v224 offset:27520
v_lshlrev_b32 v201, 16, v231
v_mfma_f32_16x16x32_bf16 v[92:95], v[176:179], a[44:47], v[92:95]
buffer_load_dwordx4 v[152:155], v213, s[24:27], s51 offen offset:2048 sc1
v_mfma_f32_16x16x32_bf16 v[92:95], v[180:183], a[48:51], v[92:95]
v_and_b32 v202, s54, v230
v_and_b32 v203, s54, v231
v_mfma_f32_16x16x32_bf16 v[64:67], v[184:187], a[24:27], v[64:67]
s_add_u32 s51, s51, 4096
ds_read_b128 a[116:119], v224 offset:27584
v_sub_f32 v200, v200, v201
v_mfma_f32_16x16x32_bf16 v[64:67], v[188:191], a[28:31], v[64:67]
buffer_load_dwordx4 v[160:163], v213, s[24:27], s51 offen offset:0 sc1
v_mfma_f32_16x16x32_bf16 v[68:71], v[184:187], a[28:31], v[68:71]
v_sub_f32 v202, v202, v203
v_mfma_f32_16x16x32_bf16 v[68:71], v[188:191], a[32:35], v[68:71]
v_cvt_pk_bf16_f32 v230, v200, v202
v_mfma_f32_16x16x32_bf16 v[72:75], v[184:187], a[32:35], v[72:75]
buffer_load_dwordx4 v[164:167], v213, s[24:27], s51 offen offset:1024 sc1
v_mfma_f32_16x16x32_bf16 v[72:75], v[188:191], a[36:39], v[72:75]
ds_write_b32 v207, v230 offset:28224
v_mfma_f32_16x16x32_bf16 v[76:79], v[184:187], a[36:39], v[76:79]
v_mfma_f32_16x16x32_bf16 v[76:79], v[188:191], a[40:43], v[76:79]
buffer_load_dwordx4 v[168:171], v213, s[24:27], s51 offen offset:2048 sc1
v_mfma_f32_16x16x32_bf16 v[80:83], v[184:187], a[40:43], v[80:83]
v_mfma_f32_16x16x32_bf16 v[80:83], v[188:191], a[44:47], v[80:83]
v_mfma_f32_16x16x32_bf16 v[84:87], v[184:187], a[44:47], v[84:87]
v_mfma_f32_16x16x32_bf16 v[84:87], v[188:191], a[48:51], v[84:87]
v_mfma_f32_16x16x32_bf16 v[88:91], v[184:187], a[48:51], v[88:91]
v_mfma_f32_16x16x32_bf16 v[88:91], v[188:191], a[52:55], v[88:91]
v_mfma_f32_16x16x32_bf16 v[92:95], v[184:187], a[52:55], v[92:95]
v_mfma_f32_16x16x32_bf16 v[92:95], v[188:191], a[56:59], v[92:95]
s_waitcnt vmcnt(16)
s_waitcnt lgkmcnt(1)
s_branch LM_ph3
.p2align 6
LM_loop:
v_mfma_f32_16x16x32_bf16 v[0:3], v[96:99], a[0:3], v[0:3]
ds_read_b128 v[192:195], v205 offset:3712
ds_read_b128 v[196:199], v225 offset:3200
v_mfma_f32_16x16x32_bf16 v[0:3], v[100:103], a[4:7], v[0:3]
buffer_load_dwordx4 v[168:171], v213, s[24:27], s51 offen offset:2048 sc1
v_mfma_f32_16x16x32_bf16 v[4:7], v[96:99], a[4:7], v[4:7]
ds_read_b128 a[60:63], v204 offset:512
v_mfma_f32_16x16x32_bf16 v[4:7], v[100:103], a[8:11], v[4:7]
v_mfma_f32_16x16x32_bf16 v[8:11], v[96:99], a[8:11], v[8:11]
v_mfma_f32_16x16x32_bf16 v[8:11], v[100:103], a[12:15], v[8:11]
buffer_load_dwordx4 v[172:175], v213, s[24:27], s51 offen offset:3072 sc1
v_mfma_f32_16x16x32_bf16 v[12:15], v[96:99], a[12:15], v[12:15]
ds_read_b128 a[64:67], v204 offset:576
s_waitcnt lgkmcnt(2)
v_mfma_f32_16x16x32_bf16 v[12:15], v[100:103], a[16:19], v[12:15]
v_lshlrev_b32 v200, 16, v192
v_lshlrev_b32 v201, 16, v196
v_mfma_f32_16x16x32_bf16 v[16:19], v[96:99], a[16:19], v[16:19]
s_add_u32 s51, s51, 4096
v_and_b32 v202, s54, v192
v_mfma_f32_16x16x32_bf16 v[16:19], v[100:103], a[20:23], v[16:19]
buffer_load_dwordx4 v[176:179], v213, s[24:27], s51 offen offset:0 sc1
v_mfma_f32_16x16x32_bf16 v[20:23], v[96:99], a[20:23], v[20:23]
ds_read_b128 a[68:71], v204 offset:640
v_and_b32 v203, s54, v196
v_mfma_f32_16x16x32_bf16 v[20:23], v[100:103], a[24:27], v[20:23]
v_sub_f32 v200, v200, v201
v_sub_f32 v202, v202, v203
v_mfma_f32_16x16x32_bf16 v[24:27], v[96:99], a[24:27], v[24:27]
ds_read_b128 a[72:75], v204 offset:704
v_cvt_pk_bf16_f32 v192, v200, v202
v_mfma_f32_16x16x32_bf16 v[24:27], v[100:103], a[28:31], v[24:27]
buffer_load_dwordx4 v[180:183], v213, s[24:27], s51 offen offset:1024 sc1
v_mfma_f32_16x16x32_bf16 v[28:31], v[96:99], a[28:31], v[28:31]
v_lshlrev_b32 v200, 16, v193
v_lshlrev_b32 v201, 16, v197
v_mfma_f32_16x16x32_bf16 v[28:31], v[100:103], a[32:35], v[28:31]
s_waitcnt vmcnt(23)
v_and_b32 v202, s54, v193
v_mfma_f32_16x16x32_bf16 v[0:3], v[104:107], a[8:11], v[0:3]
ds_read_b128 a[76:79], v204 offset:768
v_and_b32 v203, s54, v197
v_mfma_f32_16x16x32_bf16 v[0:3], v[108:111], a[12:15], v[0:3]
buffer_load_dwordx4 v[184:187], v213, s[24:27], s51 offen offset:2048 sc1
v_mfma_f32_16x16x32_bf16 v[4:7], v[104:107], a[12:15], v[4:7]
ds_read_b128 a[80:83], v204 offset:832
v_sub_f32 v200, v200, v201
v_mfma_f32_16x16x32_bf16 v[4:7], v[108:111], a[16:19], v[4:7]
v_sub_f32 v202, v202, v203
v_cvt_pk_bf16_f32 v193, v200, v202
v_mfma_f32_16x16x32_bf16 v[8:11], v[104:107], a[16:19], v[8:11]
v_lshlrev_b32 v200, 16, v194
v_lshlrev_b32 v201, 16, v198
v_mfma_f32_16x16x32_bf16 v[8:11], v[108:111], a[20:23], v[8:11]
buffer_load_dwordx4 v[188:191], v213, s[24:27], s51 offen offset:3072 sc1
v_mfma_f32_16x16x32_bf16 v[12:15], v[104:107], a[20:23], v[12:15]
ds_read_b128 a[84:87], v204 offset:896
v_mfma_f32_16x16x32_bf16 v[12:15], v[108:111], a[24:27], v[12:15]
v_and_b32 v202, s54, v194
v_mfma_f32_16x16x32_bf16 v[16:19], v[104:107], a[24:27], v[16:19]
s_add_u32 s51, s51, 4096
v_mfma_f32_16x16x32_bf16 v[16:19], v[108:111], a[28:31], v[16:19]
buffer_load_dwordx4 v[96:99], v213, s[24:27], s51 offen offset:0 sc1
v_mfma_f32_16x16x32_bf16 v[20:23], v[104:107], a[28:31], v[20:23]
ds_read_b128 a[88:91], v204 offset:960
v_mfma_f32_16x16x32_bf16 v[20:23], v[108:111], a[32:35], v[20:23]
v_and_b32 v203, s54, v198
v_mfma_f32_16x16x32_bf16 v[24:27], v[104:107], a[32:35], v[24:27]
ds_read_b128 a[92:95], v224 offset:512
v_mfma_f32_16x16x32_bf16 v[24:27], v[108:111], a[36:39], v[24:27]
buffer_load_dwordx4 v[100:103], v213, s[24:27], s51 offen offset:1024 sc1
v_mfma_f32_16x16x32_bf16 v[28:31], v[104:107], a[36:39], v[28:31]
v_sub_f32 v200, v200, v201
v_mfma_f32_16x16x32_bf16 v[28:31], v[108:111], a[40:43], v[28:31]
s_waitcnt vmcnt(25)
v_mfma_f32_16x16x32_bf16 v[0:3], v[112:115], a[16:19], v[0:3]
ds_read_b128 a[96:99], v224 offset:576
v_mfma_f32_16x16x32_bf16 v[0:3], v[116:119], a[20:23], v[0:3]
buffer_load_dwordx4 v[104:107], v213, s[24:27], s51 offen offset:2048 sc1
v_mfma_f32_16x16x32_bf16 v[4:7], v[112:115], a[20:23], v[4:7]
v_sub_f32 v202, v202, v203
v_mfma_f32_16x16x32_bf16 v[4:7], v[116:119], a[24:27], v[4:7]
ds_read_b128 a[100:103], v224 offset:640
v_mfma_f32_16x16x32_bf16 v[8:11], v[112:115], a[24:27], v[8:11]
v_cvt_pk_bf16_f32 v194, v200, v202
v_mfma_f32_16x16x32_bf16 v[8:11], v[116:119], a[28:31], v[8:11]
buffer_load_dwordx4 v[108:111], v213, s[24:27], s51 offen offset:3072 sc1
v_mfma_f32_16x16x32_bf16 v[12:15], v[112:115], a[28:31], v[12:15]
ds_read_b128 a[104:107], v224 offset:704
v_mfma_f32_16x16x32_bf16 v[12:15], v[116:119], a[32:35], v[12:15]
v_lshlrev_b32 v200, 16, v195
v_mfma_f32_16x16x32_bf16 v[16:19], v[112:115], a[32:35], v[16:19]
v_lshlrev_b32 v201, 16, v199
v_mfma_f32_16x16x32_bf16 v[16:19], v[116:119], a[36:39], v[16:19]
v_and_b32 v202, s54, v195
v_mfma_f32_16x16x32_bf16 v[20:23], v[112:115], a[36:39], v[20:23]
ds_read_b128 a[108:111], v224 offset:768
v_mfma_f32_16x16x32_bf16 v[20:23], v[116:119], a[40:43], v[20:23]
v_and_b32 v203, s54, v199
v_mfma_f32_16x16x32_bf16 v[24:27], v[112:115], a[40:43], v[24:27]
v_sub_f32 v200, v200, v201
v_mfma_f32_16x16x32_bf16 v[24:27], v[116:119], a[44:47], v[24:27]
ds_read_b128 a[112:115], v224 offset:832
v_mfma_f32_16x16x32_bf16 v[28:31], v[112:115], a[44:47], v[28:31]
v_sub_f32 v202, v202, v203
v_mfma_f32_16x16x32_bf16 v[28:31], v[116:119], a[48:51], v[28:31]
s_waitcnt vmcnt(20)
v_mfma_f32_16x16x32_bf16 v[0:3], v[120:123], a[24:27], v[0:3]
s_add_u32 s51, s51, 4096
v_mfma_f32_16x16x32_bf16 v[0:3], v[124:127], a[28:31], v[0:3]
buffer_load_dwordx4 v[112:115], v213, s[24:27], s51 offen offset:0 sc1
v_mfma_f32_16x16x32_bf16 v[4:7], v[120:123], a[28:31], v[4:7]
ds_read_b128 a[116:119], v224 offset:896
v_mfma_f32_16x16x32_bf16 v[4:7], v[124:127], a[32:35], v[4:7]
v_cvt_pk_bf16_f32 v195, v200, v202
v_mfma_f32_16x16x32_bf16 v[8:11], v[120:123], a[32:35], v[8:11]
ds_write_b128 v205, v[192:195] offset:4224
v_mfma_f32_16x16x32_bf16 v[8:11], v[124:127], a[36:39], v[8:11]
buffer_load_dwordx4 v[116:119], v213, s[24:27], s51 offen offset:1024 sc1
v_mfma_f32_16x16x32_bf16 v[12:15], v[120:123], a[36:39], v[12:15]
v_mfma_f32_16x16x32_bf16 v[12:15], v[124:127], a[40:43], v[12:15]
v_mfma_f32_16x16x32_bf16 v[16:19], v[120:123], a[40:43], v[16:19]
v_mfma_f32_16x16x32_bf16 v[16:19], v[124:127], a[44:47], v[16:19]
v_mfma_f32_16x16x32_bf16 v[20:23], v[120:123], a[44:47], v[20:23]
v_mfma_f32_16x16x32_bf16 v[20:23], v[124:127], a[48:51], v[20:23]
v_mfma_f32_16x16x32_bf16 v[24:27], v[120:123], a[48:51], v[24:27]
v_mfma_f32_16x16x32_bf16 v[24:27], v[124:127], a[52:55], v[24:27]
v_mfma_f32_16x16x32_bf16 v[28:31], v[120:123], a[52:55], v[28:31]
v_mfma_f32_16x16x32_bf16 v[28:31], v[124:127], a[56:59], v[28:31]
s_waitcnt vmcnt(20)
s_waitcnt lgkmcnt(0)
s_barrier
v_mfma_f32_16x16x32_bf16 v[32:35], v[128:131], a[60:63], v[32:35]
s_add_u32 m0, s53, 0
v_mfma_f32_16x16x32_bf16 v[32:35], v[132:135], a[64:67], v[32:35]
buffer_load_dwordx4 v208, s[20:23], s49 offen lds
v_mfma_f32_16x16x32_bf16 v[36:39], v[128:131], a[64:67], v[36:39]
ds_read_b128 a[0:3], v204 offset:1024
v_mfma_f32_16x16x32_bf16 v[36:39], v[132:135], a[68:71], v[36:39]
s_add_u32 m0, s53, 6400
v_mfma_f32_16x16x32_bf16 v[40:43], v[128:131], a[68:71], v[40:43]
buffer_load_dwordx4 v209, s[20:23], s49 offen lds
v_mfma_f32_16x16x32_bf16 v[40:43], v[132:135], a[72:75], v[40:43]
ds_read_b128 a[4:7], v204 offset:1088
v_mfma_f32_16x16x32_bf16 v[44:47], v[128:131], a[72:75], v[44:47]
s_add_u32 m0, s53, 12800
v_mfma_f32_16x16x32_bf16 v[44:47], v[132:135], a[76:79], v[44:47]
buffer_load_dwordx4 v210, s[20:23], s49 offen lds
v_mfma_f32_16x16x32_bf16 v[48:51], v[128:131], a[76:79], v[48:51]
ds_read_b128 a[8:11], v204 offset:1152
v_mfma_f32_16x16x32_bf16 v[48:51], v[132:135], a[80:83], v[48:51]
s_add_u32 m0, s53, 19200
v_mfma_f32_16x16x32_bf16 v[52:55], v[128:131], a[80:83], v[52:55]
buffer_load_dwordx4 v211, s[20:23], s49 offen lds
v_mfma_f32_16x16x32_bf16 v[52:55], v[132:135], a[84:87], v[52:55]
v_mfma_f32_16x16x32_bf16 v[56:59], v[128:131], a[84:87], v[56:59]
s_add_u32 m0, s55, 0
v_mfma_f32_16x16x32_bf16 v[56:59], v[132:135], a[88:91], v[56:59]
buffer_load_dword v212, s[20:23], s49 offen lds
v_mfma_f32_16x16x32_bf16 v[60:63], v[128:131], a[88:91], v[60:63]
ds_read_b128 a[12:15], v204 offset:1216
v_mfma_f32_16x16x32_bf16 v[60:63], v[132:135], a[92:95], v[60:63]
s_waitcnt vmcnt(23)
v_mfma_f32_16x16x32_bf16 v[32:35], v[136:139], a[68:71], v[32:35]
ds_read_b128 a[16:19], v204 offset:1280
v_mfma_f32_16x16x32_bf16 v[32:35], v[140:143], a[72:75], v[32:35]
v_mfma_f32_16x16x32_bf16 v[36:39], v[136:139], a[72:75], v[36:39]
ds_read_b128 a[20:23], v204 offset:1344
v_mfma_f32_16x16x32_bf16 v[36:39], v[140:143], a[76:79], v[36:39]
v_mfma_f32_16x16x32_bf16 v[40:43], v[136:139], a[76:79], v[40:43]
v_mfma_f32_16x16x32_bf16 v[40:43], v[140:143], a[80:83], v[40:43]
v_mfma_f32_16x16x32_bf16 v[44:47], v[136:139], a[80:83], v[44:47]
ds_read_b128 a[24:27], v204 offset:1408
v_mfma_f32_16x16x32_bf16 v[44:47], v[140:143], a[84:87], v[44:47]
v_mfma_f32_16x16x32_bf16 v[48:51], v[136:139], a[84:87], v[48:51]
v_mfma_f32_16x16x32_bf16 v[48:51], v[140:143], a[88:91], v[48:51]
ds_read_b128 a[28:31], v204 offset:1472
v_mfma_f32_16x16x32_bf16 v[52:55], v[136:139], a[88:91], v[52:55]
v_mfma_f32_16x16x32_bf16 v[52:55], v[140:143], a[92:95], v[52:55]
v_mfma_f32_16x16x32_bf16 v[56:59], v[136:139], a[92:95], v[56:59]
ds_read_b128 a[32:35], v224 offset:1024
v_mfma_f32_16x16x32_bf16 v[56:59], v[140:143], a[96:99], v[56:59]
v_mfma_f32_16x16x32_bf16 v[60:63], v[136:139], a[96:99], v[60:63]
v_mfma_f32_16x16x32_bf16 v[60:63], v[140:143], a[100:103], v[60:63]
s_waitcnt vmcnt(21)
v_mfma_f32_16x16x32_bf16 v[32:35], v[144:147], a[76:79], v[32:35]
ds_read_b128 a[36:39], v224 offset:1088
v_mfma_f32_16x16x32_bf16 v[32:35], v[148:151], a[80:83], v[32:35]
v_mfma_f32_16x16x32_bf16 v[36:39], v[144:147], a[80:83], v[36:39]
v_mfma_f32_16x16x32_bf16 v[36:39], v[148:151], a[84:87], v[36:39]
ds_read_b128 a[40:43], v224 offset:1152
v_mfma_f32_16x16x32_bf16 v[40:43], v[144:147], a[84:87], v[40:43]
v_mfma_f32_16x16x32_bf16 v[40:43], v[148:151], a[88:91], v[40:43]
v_mfma_f32_16x16x32_bf16 v[44:47], v[144:147], a[88:91], v[44:47]
ds_read_b128 a[44:47], v224 offset:1216
v_mfma_f32_16x16x32_bf16 v[44:47], v[148:151], a[92:95], v[44:47]
v_mfma_f32_16x16x32_bf16 v[48:51], v[144:147], a[92:95], v[48:51]
v_mfma_f32_16x16x32_bf16 v[48:51], v[148:151], a[96:99], v[48:51]
v_mfma_f32_16x16x32_bf16 v[52:55], v[144:147], a[96:99], v[52:55]
ds_read_b128 a[48:51], v224 offset:1280
v_mfma_f32_16x16x32_bf16 v[52:55], v[148:151], a[100:103], v[52:55]
v_mfma_f32_16x16x32_bf16 v[56:59], v[144:147], a[100:103], v[56:59]
v_mfma_f32_16x16x32_bf16 v[56:59], v[148:151], a[104:107], v[56:59]
ds_read_b128 a[52:55], v224 offset:1344
v_mfma_f32_16x16x32_bf16 v[60:63], v[144:147], a[104:107], v[60:63]
v_mfma_f32_16x16x32_bf16 v[60:63], v[148:151], a[108:111], v[60:63]
s_waitcnt vmcnt(19)
v_mfma_f32_16x16x32_bf16 v[32:35], v[152:155], a[84:87], v[32:35]
ds_read_b128 a[56:59], v224 offset:1408
v_mfma_f32_16x16x32_bf16 v[32:35], v[156:159], a[88:91], v[32:35]
v_mfma_f32_16x16x32_bf16 v[36:39], v[152:155], a[88:91], v[36:39]
v_mfma_f32_16x16x32_bf16 v[36:39], v[156:159], a[92:95], v[36:39]
v_mfma_f32_16x16x32_bf16 v[40:43], v[152:155], a[92:95], v[40:43]
v_mfma_f32_16x16x32_bf16 v[40:43], v[156:159], a[96:99], v[40:43]
v_mfma_f32_16x16x32_bf16 v[44:47], v[152:155], a[96:99], v[44:47]
v_mfma_f32_16x16x32_bf16 v[44:47], v[156:159], a[100:103], v[44:47]
v_mfma_f32_16x16x32_bf16 v[48:51], v[152:155], a[100:103], v[48:51]
v_mfma_f32_16x16x32_bf16 v[48:51], v[156:159], a[104:107], v[48:51]
v_mfma_f32_16x16x32_bf16 v[52:55], v[152:155], a[104:107], v[52:55]
v_mfma_f32_16x16x32_bf16 v[52:55], v[156:159], a[108:111], v[52:55]
v_mfma_f32_16x16x32_bf16 v[56:59], v[152:155], a[108:111], v[56:59]
v_mfma_f32_16x16x32_bf16 v[56:59], v[156:159], a[112:115], v[56:59]
v_mfma_f32_16x16x32_bf16 v[60:63], v[152:155], a[112:115], v[60:63]
v_mfma_f32_16x16x32_bf16 v[60:63], v[156:159], a[116:119], v[60:63]
s_waitcnt vmcnt(17)
s_waitcnt lgkmcnt(0)
v_mfma_f32_16x16x32_bf16 v[64:67], v[160:163], a[0:3], v[64:67]
ds_read_b128 v[192:195], v205 offset:27712
ds_read_b128 v[196:199], v206 offset:27200
v_mfma_f32_16x16x32_bf16 v[64:67], v[164:167], a[4:7], v[64:67]
ds_read_b32 v230, v207 offset:27712
ds_read_b32 v231, v207 offset:27264
v_mfma_f32_16x16x32_bf16 v[68:71], v[160:163], a[4:7], v[68:71]
ds_read_b128 a[60:63], v204 offset:27200
v_mfma_f32_16x16x32_bf16 v[68:71], v[164:167], a[8:11], v[68:71]
v_mfma_f32_16x16x32_bf16 v[72:75], v[160:163], a[8:11], v[72:75]
v_mfma_f32_16x16x32_bf16 v[72:75], v[164:167], a[12:15], v[72:75]
ds_read_b128 a[64:67], v204 offset:27264
v_mfma_f32_16x16x32_bf16 v[76:79], v[160:163], a[12:15], v[76:79]
v_mfma_f32_16x16x32_bf16 v[76:79], v[164:167], a[16:19], v[76:79]
s_waitcnt lgkmcnt(4)
v_lshlrev_b32 v200, 16, v192
v_mfma_f32_16x16x32_bf16 v[80:83], v[160:163], a[16:19], v[80:83]
ds_read_b128 a[68:71], v204 offset:27328
v_lshlrev_b32 v201, 16, v196
v_mfma_f32_16x16x32_bf16 v[80:83], v[164:167], a[20:23], v[80:83]
v_and_b32 v202, s54, v192
v_and_b32 v203, s54, v196
v_mfma_f32_16x16x32_bf16 v[84:87], v[160:163], a[20:23], v[84:87]
v_sub_f32 v200, v200, v201
v_sub_f32 v202, v202, v203
v_mfma_f32_16x16x32_bf16 v[84:87], v[164:167], a[24:27], v[84:87]
v_cvt_pk_bf16_f32 v192, v200, v202
v_lshlrev_b32 v200, 16, v193
v_mfma_f32_16x16x32_bf16 v[88:91], v[160:163], a[24:27], v[88:91]
ds_read_b128 a[72:75], v204 offset:27392
v_lshlrev_b32 v201, 16, v197
v_mfma_f32_16x16x32_bf16 v[88:91], v[164:167], a[28:31], v[88:91]
v_and_b32 v202, s54, v193
v_and_b32 v203, s54, v197
v_mfma_f32_16x16x32_bf16 v[92:95], v[160:163], a[28:31], v[92:95]
v_sub_f32 v200, v200, v201
v_sub_f32 v202, v202, v203
v_mfma_f32_16x16x32_bf16 v[92:95], v[164:167], a[32:35], v[92:95]
s_waitcnt vmcnt(15)
v_cvt_pk_bf16_f32 v193, v200, v202
v_mfma_f32_16x16x32_bf16 v[64:67], v[168:171], a[8:11], v[64:67]
ds_read_b128 a[76:79], v204 offset:27456
v_lshlrev_b32 v200, 16, v194
v_mfma_f32_16x16x32_bf16 v[64:67], v[172:175], a[12:15], v[64:67]
buffer_load_dwordx4 v[120:123], v213, s[24:27], s51 offen offset:2048 sc1
v_mfma_f32_16x16x32_bf16 v[68:71], v[168:171], a[12:15], v[68:71]
ds_read_b128 a[80:83], v204 offset:27520
v_lshlrev_b32 v201, 16, v198
v_mfma_f32_16x16x32_bf16 v[68:71], v[172:175], a[16:19], v[68:71]
v_and_b32 v202, s54, v194
v_and_b32 v203, s54, v198
v_mfma_f32_16x16x32_bf16 v[72:75], v[168:171], a[16:19], v[72:75]
v_sub_f32 v200, v200, v201
v_sub_f32 v202, v202, v203
v_mfma_f32_16x16x32_bf16 v[72:75], v[172:175], a[20:23], v[72:75]
buffer_load_dwordx4 v[124:127], v213, s[24:27], s51 offen offset:3072 sc1
v_mfma_f32_16x16x32_bf16 v[76:79], v[168:171], a[20:23], v[76:79]
ds_read_b128 a[84:87], v204 offset:27584
v_cvt_pk_bf16_f32 v194, v200, v202
v_mfma_f32_16x16x32_bf16 v[76:79], v[172:175], a[24:27], v[76:79]
v_lshlrev_b32 v200, 16, v195
v_lshlrev_b32 v201, 16, v199
v_mfma_f32_16x16x32_bf16 v[80:83], v[168:171], a[24:27], v[80:83]
s_add_u32 s51, s51, 4096
v_and_b32 v202, s54, v195
v_mfma_f32_16x16x32_bf16 v[80:83], v[172:175], a[28:31], v[80:83]
buffer_load_dwordx4 v[128:131], v213, s[24:27], s51 offen offset:0 sc1
v_mfma_f32_16x16x32_bf16 v[84:87], v[168:171], a[28:31], v[84:87]
ds_read_b128 a[88:91], v204 offset:27648
v_and_b32 v203, s54, v199
v_mfma_f32_16x16x32_bf16 v[84:87], v[172:175], a[32:35], v[84:87]
v_sub_f32 v200, v200, v201
v_sub_f32 v202, v202, v203
v_mfma_f32_16x16x32_bf16 v[88:91], v[168:171], a[32:35], v[88:91]
ds_read_b128 a[92:95], v224 offset:27200
v_cvt_pk_bf16_f32 v195, v200, v202
v_mfma_f32_16x16x32_bf16 v[88:91], v[172:175], a[36:39], v[88:91]
buffer_load_dwordx4 v[132:135], v213, s[24:27], s51 offen offset:1024 sc1
v_mfma_f32_16x16x32_bf16 v[92:95], v[168:171], a[36:39], v[92:95]
ds_write_b128 v205, v[192:195] offset:28224
s_waitcnt lgkmcnt(10)
v_mfma_f32_16x16x32_bf16 v[92:95], v[172:175], a[40:43], v[92:95]
s_waitcnt vmcnt(17)
v_lshlrev_b32 v200, 16, v230
v_mfma_f32_16x16x32_bf16 v[64:67], v[176:179], a[16:19], v[64:67]
ds_read_b128 a[96:99], v224 offset:27264
v_mfma_f32_16x16x32_bf16 v[64:67], v[180:183], a[20:23], v[64:67]
buffer_load_dwordx4 v[136:139], v213, s[24:27], s51 offen offset:2048 sc1
v_mfma_f32_16x16x32_bf16 v[68:71], v[176:179], a[20:23], v[68:71]
v_lshlrev_b32 v201, 16, v231
v_mfma_f32_16x16x32_bf16 v[68:71], v[180:183], a[24:27], v[68:71]
ds_read_b128 a[100:103], v224 offset:27328
v_mfma_f32_16x16x32_bf16 v[72:75], v[176:179], a[24:27], v[72:75]
v_and_b32 v202, s54, v230
v_mfma_f32_16x16x32_bf16 v[72:75], v[180:183], a[28:31], v[72:75]
buffer_load_dwordx4 v[140:143], v213, s[24:27], s51 offen offset:3072 sc1
v_mfma_f32_16x16x32_bf16 v[76:79], v[176:179], a[28:31], v[76:79]
ds_read_b128 a[104:107], v224 offset:27392
v_mfma_f32_16x16x32_bf16 v[76:79], v[180:183], a[32:35], v[76:79]
v_and_b32 v203, s54, v231
v_mfma_f32_16x16x32_bf16 v[80:83], v[176:179], a[32:35], v[80:83]
s_add_u32 s51, s51, 4096
v_mfma_f32_16x16x32_bf16 v[80:83], v[180:183], a[36:39], v[80:83]
buffer_load_dwordx4 v[144:147], v213, s[24:27], s51 offen offset:0 sc1
v_mfma_f32_16x16x32_bf16 v[84:87], v[176:179], a[36:39], v[84:87]
ds_read_b128 a[108:111], v224 offset:27456
v_mfma_f32_16x16x32_bf16 v[84:87], v[180:183], a[40:43], v[84:87]
v_sub_f32 v200, v200, v201
v_mfma_f32_16x16x32_bf16 v[88:91], v[176:179], a[40:43], v[88:91]
v_sub_f32 v202, v202, v203
v_mfma_f32_16x16x32_bf16 v[88:91], v[180:183], a[44:47], v[88:91]
buffer_load_dwordx4 v[148:151], v213, s[24:27], s51 offen offset:1024 sc1
v_mfma_f32_16x16x32_bf16 v[92:95], v[176:179], a[44:47], v[92:95]
ds_read_b128 a[112:115], v224 offset:27520
v_mfma_f32_16x16x32_bf16 v[92:95], v[180:183], a[48:51], v[92:95]
s_waitcnt vmcnt(19)
v_mfma_f32_16x16x32_bf16 v[64:67], v[184:187], a[24:27], v[64:67]
ds_read_b128 a[116:119], v224 offset:27584
v_mfma_f32_16x16x32_bf16 v[64:67], v[188:191], a[28:31], v[64:67]
buffer_load_dwordx4 v[152:155], v213, s[24:27], s51 offen offset:2048 sc1
v_mfma_f32_16x16x32_bf16 v[68:71], v[184:187], a[28:31], v[68:71]
v_cvt_pk_bf16_f32 v230, v200, v202
v_mfma_f32_16x16x32_bf16 v[68:71], v[188:191], a[32:35], v[68:71]
ds_write_b32 v207, v230 offset:28224
v_mfma_f32_16x16x32_bf16 v[72:75], v[184:187], a[32:35], v[72:75]
s_add_u32 s51, s51, 4096
v_mfma_f32_16x16x32_bf16 v[72:75], v[188:191], a[36:39], v[72:75]
buffer_load_dwordx4 v[160:163], v213, s[24:27], s51 offen offset:0 sc1
v_mfma_f32_16x16x32_bf16 v[76:79], v[184:187], a[36:39], v[76:79]
v_mfma_f32_16x16x32_bf16 v[76:79], v[188:191], a[40:43], v[76:79]
v_mfma_f32_16x16x32_bf16 v[80:83], v[184:187], a[40:43], v[80:83]
v_mfma_f32_16x16x32_bf16 v[80:83], v[188:191], a[44:47], v[80:83]
buffer_load_dwordx4 v[164:167], v213, s[24:27], s51 offen offset:1024 sc1
v_mfma_f32_16x16x32_bf16 v[84:87], v[184:187], a[44:47], v[84:87]
v_mfma_f32_16x16x32_bf16 v[84:87], v[188:191], a[48:51], v[84:87]
v_mfma_f32_16x16x32_bf16 v[88:91], v[184:187], a[48:51], v[88:91]
v_mfma_f32_16x16x32_bf16 v[88:91], v[188:191], a[52:55], v[88:91]
buffer_load_dwordx4 v[168:171], v213, s[24:27], s51 offen offset:2048 sc1
v_mfma_f32_16x16x32_bf16 v[92:95], v[184:187], a[52:55], v[92:95]
v_mfma_f32_16x16x32_bf16 v[92:95], v[188:191], a[56:59], v[92:95]
s_waitcnt vmcnt(21)
s_waitcnt lgkmcnt(1)
LM_ph3:
v_mfma_f32_16x16x32_bf16 v[0:3], v[96:99], a[60:63], v[0:3]
ds_read_b128 v[192:195], v205 offset:30912
ds_read_b128 v[196:199], v225 offset:30400
v_mfma_f32_16x16x32_bf16 v[0:3], v[100:103], a[64:67], v[0:3]
buffer_load_dwordx4 v[172:175], v213, s[24:27], s51 offen offset:3072 sc1
v_mfma_f32_16x16x32_bf16 v[4:7], v[96:99], a[64:67], v[4:7]
ds_read_b128 a[0:3], v204 offset:27712
v_mfma_f32_16x16x32_bf16 v[4:7], v[100:103], a[68:71], v[4:7]
v_mfma_f32_16x16x32_bf16 v[8:11], v[96:99], a[68:71], v[8:11]
s_add_u32 s51, s51, 4096
v_mfma_f32_16x16x32_bf16 v[8:11], v[100:103], a[72:75], v[8:11]
buffer_load_dwordx4 v[176:179], v213, s[24:27], s51 offen offset:0 sc1
v_mfma_f32_16x16x32_bf16 v[12:15], v[96:99], a[72:75], v[12:15]
ds_read_b128 a[4:7], v204 offset:27776
s_waitcnt lgkmcnt(2)
v_mfma_f32_16x16x32_bf16 v[12:15], v[100:103], a[76:79], v[12:15]
v_lshlrev_b32 v200, 16, v192
v_lshlrev_b32 v201, 16, v196
v_mfma_f32_16x16x32_bf16 v[16:19], v[96:99], a[76:79], v[16:19]
v_and_b32 v202, s54, v192
v_and_b32 v203, s54, v196
v_mfma_f32_16x16x32_bf16 v[16:19], v[100:103], a[80:83], v[16:19]
buffer_load_dwordx4 v[180:183], v213, s[24:27], s51 offen offset:1024 sc1
v_mfma_f32_16x16x32_bf16 v[20:23], v[96:99], a[80:83], v[20:23]
ds_read_b128 a[8:11], v204 offset:27840
v_sub_f32 v200, v200, v201
v_mfma_f32_16x16x32_bf16 v[20:23], v[100:103], a[84:87], v[20:23]
v_sub_f32 v202, v202, v203
v_cvt_pk_bf16_f32 v192, v200, v202
v_mfma_f32_16x16x32_bf16 v[24:27], v[96:99], a[84:87], v[24:27]
ds_read_b128 a[12:15], v204 offset:27904
v_lshlrev_b32 v200, 16, v193
v_mfma_f32_16x16x32_bf16 v[24:27], v[100:103], a[88:91], v[24:27]
buffer_load_dwordx4 v[184:187], v213, s[24:27], s51 offen offset:2048 sc1
v_mfma_f32_16x16x32_bf16 v[28:31], v[96:99], a[88:91], v[28:31]
v_lshlrev_b32 v201, 16, v197
v_and_b32 v202, s54, v193
v_mfma_f32_16x16x32_bf16 v[28:31], v[100:103], a[92:95], v[28:31]
s_waitcnt vmcnt(18)
v_and_b32 v203, s54, v197
v_mfma_f32_16x16x32_bf16 v[0:3], v[104:107], a[68:71], v[0:3]
ds_read_b128 a[16:19], v204 offset:27968
v_sub_f32 v200, v200, v201
v_mfma_f32_16x16x32_bf16 v[0:3], v[108:111], a[72:75], v[0:3]
buffer_load_dwordx4 v[188:191], v213, s[24:27], s51 offen offset:3072 sc1
v_mfma_f32_16x16x32_bf16 v[4:7], v[104:107], a[72:75], v[4:7]
v_sub_f32 v202, v202, v203
v_mfma_f32_16x16x32_bf16 v[4:7], v[108:111], a[76:79], v[4:7]
ds_read_b128 a[20:23], v204 offset:28032
v_mfma_f32_16x16x32_bf16 v[8:11], v[104:107], a[76:79], v[8:11]
s_add_u32 s51, s51, 4096
v_mfma_f32_16x16x32_bf16 v[8:11], v[108:111], a[80:83], v[8:11]
buffer_load_dwordx4 v[96:99], v213, s[24:27], s51 offen offset:0 sc1
v_mfma_f32_16x16x32_bf16 v[12:15], v[104:107], a[80:83], v[12:15]
v_cvt_pk_bf16_f32 v193, v200, v202
v_mfma_f32_16x16x32_bf16 v[12:15], v[108:111], a[84:87], v[12:15]
ds_read_b128 a[24:27], v204 offset:28096
v_mfma_f32_16x16x32_bf16 v[16:19], v[104:107], a[84:87], v[16:19]
v_lshlrev_b32 v200, 16, v194
v_mfma_f32_16x16x32_bf16 v[16:19], v[108:111], a[88:91], v[16:19]
buffer_load_dwordx4 v[100:103], v213, s[24:27], s51 offen offset:1024 sc1
v_mfma_f32_16x16x32_bf16 v[20:23], v[104:107], a[88:91], v[20:23]
v_lshlrev_b32 v201, 16, v198
v_mfma_f32_16x16x32_bf16 v[20:23], v[108:111], a[92:95], v[20:23]
ds_read_b128 a[28:31], v204 offset:28160
v_mfma_f32_16x16x32_bf16 v[24:27], v[104:107], a[92:95], v[24:27]
v_and_b32 v202, s54, v194
v_mfma_f32_16x16x32_bf16 v[24:27], v[108:111], a[96:99], v[24:27]
v_and_b32 v203, s54, v198
v_mfma_f32_16x16x32_bf16 v[28:31], v[104:107], a[96:99], v[28:31]
ds_read_b128 a[32:35], v224 offset:27712
v_mfma_f32_16x16x32_bf16 v[28:31], v[108:111], a[100:103], v[28:31]
s_waitcnt vmcnt(19)
v_mfma_f32_16x16x32_bf16 v[0:3], v[112:115], a[76:79], v[0:3]
v_sub_f32 v200, v200, v201
v_mfma_f32_16x16x32_bf16 v[0:3], v[116:119], a[80:83], v[0:3]
buffer_load_dwordx4 v[104:107], v213, s[24:27], s51 offen offset:2048 sc1
v_mfma_f32_16x16x32_bf16 v[4:7], v[112:115], a[80:83], v[4:7]
ds_read_b128 a[36:39], v224 offset:27776
v_mfma_f32_16x16x32_bf16 v[4:7], v[116:119], a[84:87], v[4:7]
v_sub_f32 v202, v202, v203
v_mfma_f32_16x16x32_bf16 v[8:11], v[112:115], a[84:87], v[8:11]
v_cvt_pk_bf16_f32 v194, v200, v202
v_mfma_f32_16x16x32_bf16 v[8:11], v[116:119], a[88:91], v[8:11]
buffer_load_dwordx4 v[108:111], v213, s[24:27], s51 offen offset:3072 sc1
v_mfma_f32_16x16x32_bf16 v[12:15], v[112:115], a[88:91], v[12:15]
ds_read_b128 a[40:43], v224 offset:27840
v_mfma_f32_16x16x32_bf16 v[12:15], v[116:119], a[92:95], v[12:15]
v_lshlrev_b32 v200, 16, v195
v_mfma_f32_16x16x32_bf16 v[16:19], v[112:115], a[92:95], v[16:19]
v_lshlrev_b32 v201, 16, v199
v_mfma_f32_16x16x32_bf16 v[16:19], v[116:119], a[96:99], v[16:19]
ds_read_b128 a[44:47], v224 offset:27904
v_mfma_f32_16x16x32_bf16 v[20:23], v[112:115], a[96:99], v[20:23]
v_and_b32 v202, s54, v195
v_mfma_f32_16x16x32_bf16 v[20:23], v[116:119], a[100:103], v[20:23]
v_and_b32 v203, s54, v199
v_mfma_f32_16x16x32_bf16 v[24:27], v[112:115], a[100:103], v[24:27]
ds_read_b128 a[48:51], v224 offset:27968
v_mfma_f32_16x16x32_bf16 v[24:27], v[116:119], a[104:107], v[24:27]
v_sub_f32 v200, v200, v201
v_mfma_f32_16x16x32_bf16 v[28:31], v[112:115], a[104:107], v[28:31]
v_sub_f32 v202, v202, v203
v_mfma_f32_16x16x32_bf16 v[28:31], v[116:119], a[108:111], v[28:31]
s_waitcnt vmcnt(19)
v_mfma_f32_16x16x32_bf16 v[0:3], v[120:123], a[84:87], v[0:3]
s_add_u32 s51, s51, 4096
v_mfma_f32_16x16x32_bf16 v[0:3], v[124:127], a[88:91], v[0:3]
buffer_load_dwordx4 v[112:115], v213, s[24:27], s51 offen offset:0 sc1
v_mfma_f32_16x16x32_bf16 v[4:7], v[120:123], a[88:91], v[4:7]
ds_read_b128 a[52:55], v224 offset:28032
v_mfma_f32_16x16x32_bf16 v[4:7], v[124:127], a[92:95], v[4:7]
v_cvt_pk_bf16_f32 v195, v200, v202
v_mfma_f32_16x16x32_bf16 v[8:11], v[120:123], a[92:95], v[8:11]
ds_write_b128 v205, v[192:195] offset:31424
v_mfma_f32_16x16x32_bf16 v[8:11], v[124:127], a[96:99], v[8:11]
buffer_load_dwordx4 v[116:119], v213, s[24:27], s51 offen offset:1024 sc1
v_mfma_f32_16x16x32_bf16 v[12:15], v[120:123], a[96:99], v[12:15]
v_mfma_f32_16x16x32_bf16 v[12:15], v[124:127], a[100:103], v[12:15]
v_mfma_f32_16x16x32_bf16 v[16:19], v[120:123], a[100:103], v[16:19]
v_mfma_f32_16x16x32_bf16 v[16:19], v[124:127], a[104:107], v[16:19]
v_mfma_f32_16x16x32_bf16 v[20:23], v[120:123], a[104:107], v[20:23]
v_mfma_f32_16x16x32_bf16 v[20:23], v[124:127], a[108:111], v[20:23]
v_mfma_f32_16x16x32_bf16 v[24:27], v[120:123], a[108:111], v[24:27]
v_mfma_f32_16x16x32_bf16 v[24:27], v[124:127], a[112:115], v[24:27]
v_mfma_f32_16x16x32_bf16 v[28:31], v[120:123], a[112:115], v[28:31]
v_mfma_f32_16x16x32_bf16 v[28:31], v[124:127], a[116:119], v[28:31]
s_waitcnt vmcnt(19)
s_waitcnt lgkmcnt(0)
s_barrier
v_mfma_f32_16x16x32_bf16 v[32:35], v[128:131], a[0:3], v[32:35]
s_add_u32 m0, s53, 27200
v_mfma_f32_16x16x32_bf16 v[32:35], v[132:135], a[4:7], v[32:35]
buffer_load_dwordx4 v208, s[20:23], s50 offen lds
v_mfma_f32_16x16x32_bf16 v[36:39], v[128:131], a[4:7], v[36:39]
ds_read_b128 a[60:63], v204 offset:28224
v_mfma_f32_16x16x32_bf16 v[36:39], v[132:135], a[8:11], v[36:39]
s_add_u32 m0, s53, 33600
v_mfma_f32_16x16x32_bf16 v[40:43], v[128:131], a[8:11], v[40:43]
buffer_load_dwordx4 v209, s[20:23], s50 offen lds
v_mfma_f32_16x16x32_bf16 v[40:43], v[132:135], a[12:15], v[40:43]
ds_read_b128 a[64:67], v204 offset:28288
v_mfma_f32_16x16x32_bf16 v[44:47], v[128:131], a[12:15], v[44:47]
s_add_u32 m0, s53, 40000
v_mfma_f32_16x16x32_bf16 v[44:47], v[132:135], a[16:19], v[44:47]
buffer_load_dwordx4 v210, s[20:23], s50 offen lds
v_mfma_f32_16x16x32_bf16 v[48:51], v[128:131], a[16:19], v[48:51]
ds_read_b128 a[68:71], v204 offset:28352
v_mfma_f32_16x16x32_bf16 v[48:51], v[132:135], a[20:23], v[48:51]
s_add_u32 m0, s53, 46400
v_mfma_f32_16x16x32_bf16 v[52:55], v[128:131], a[20:23], v[52:55]
buffer_load_dwordx4 v211, s[20:23], s50 offen lds
v_mfma_f32_16x16x32_bf16 v[52:55], v[132:135], a[24:27], v[52:55]
ds_read_b128 a[72:75], v204 offset:28416
v_mfma_f32_16x16x32_bf16 v[56:59], v[128:131], a[24:27], v[56:59]
s_add_u32 m0, s55, 27200
v_mfma_f32_16x16x32_bf16 v[56:59], v[132:135], a[28:31], v[56:59]
buffer_load_dword v212, s[20:23], s50 offen lds
v_mfma_f32_16x16x32_bf16 v[60:63], v[128:131], a[28:31], v[60:63]
ds_read_b128 a[76:79], v204 offset:28480
v_mfma_f32_16x16x32_bf16 v[60:63], v[132:135], a[32:35], v[60:63]
s_waitcnt vmcnt(22)
v_mfma_f32_16x16x32_bf16 v[32:35], v[136:139], a[8:11], v[32:35]
ds_read_b128 a[80:83], v204 offset:28544
v_mfma_f32_16x16x32_bf16 v[32:35], v[140:143], a[12:15], v[32:35]
v_mfma_f32_16x16x32_bf16 v[36:39], v[136:139], a[12:15], v[36:39]
ds_read_b128 a[84:87], v204 offset:28608
v_mfma_f32_16x16x32_bf16 v[36:39], v[140:143], a[16:19], v[36:39]
v_mfma_f32_16x16x32_bf16 v[40:43], v[136:139], a[16:19], v[40:43]
v_mfma_f32_16x16x32_bf16 v[40:43], v[140:143], a[20:23], v[40:43]
ds_read_b128 a[88:91], v204 offset:28672
v_mfma_f32_16x16x32_bf16 v[44:47], v[136:139], a[20:23], v[44:47]
v_mfma_f32_16x16x32_bf16 v[44:47], v[140:143], a[24:27], v[44:47]
v_mfma_f32_16x16x32_bf16 v[48:51], v[136:139], a[24:27], v[48:51]
ds_read_b128 a[92:95], v224 offset:28224
v_mfma_f32_16x16x32_bf16 v[48:51], v[140:143], a[28:31], v[48:51]
v_mfma_f32_16x16x32_bf16 v[52:55], v[136:139], a[28:31], v[52:55]
v_mfma_f32_16x16x32_bf16 v[52:55], v[140:143], a[32:35], v[52:55]
ds_read_b128 a[96:99], v224 offset:28288
v_mfma_f32_16x16x32_bf16 v[56:59], v[136:139], a[32:35], v[56:59]
v_mfma_f32_16x16x32_bf16 v[56:59], v[140:143], a[36:39], v[56:59]
v_mfma_f32_16x16x32_bf16 v[60:63], v[136:139], a[36:39], v[60:63]
ds_read_b128 a[100:103], v224 offset:28352
v_mfma_f32_16x16x32_bf16 v[60:63], v[140:143], a[40:43], v[60:63]
s_waitcnt vmcnt(20)
v_mfma_f32_16x16x32_bf16 v[32:35], v[144:147], a[16:19], v[32:35]
ds_read_b128 a[104:107], v224 offset:28416
v_mfma_f32_16x16x32_bf16 v[32:35], v[148:151], a[20:23], v[32:35]
v_mfma_f32_16x16x32_bf16 v[36:39], v[144:147], a[20:23], v[36:39]
v_mfma_f32_16x16x32_bf16 v[36:39], v[148:151], a[24:27], v[36:39]
ds_read_b128 a[108:111], v224 offset:28480
v_mfma_f32_16x16x32_bf16 v[40:43], v[144:147], a[24:27], v[40:43]
v_mfma_f32_16x16x32_bf16 v[40:43], v[148:151], a[28:31], v[40:43]
v_mfma_f32_16x16x32_bf16 v[44:47], v[144:147], a[28:31], v[44:47]
ds_read_b128 a[112:115], v224 offset:28544
v_mfma_f32_16x16x32_bf16 v[44:47], v[148:151], a[32:35], v[44:47]
v_mfma_f32_16x16x32_bf16 v[48:51], v[144:147], a[32:35], v[48:51]
v_mfma_f32_16x16x32_bf16 v[48:51], v[148:151], a[36:39], v[48:51]
ds_read_b128 a[116:119], v224 offset:28608
v_mfma_f32_16x16x32_bf16 v[52:55], v[144:147], a[36:39], v[52:55]
v_mfma_f32_16x16x32_bf16 v[52:55], v[148:151], a[40:43], v[52:55]
v_mfma_f32_16x16x32_bf16 v[56:59], v[144:147], a[40:43], v[56:59]
v_mfma_f32_16x16x32_bf16 v[56:59], v[148:151], a[44:47], v[56:59]
v_mfma_f32_16x16x32_bf16 v[60:63], v[144:147], a[44:47], v[60:63]
v_mfma_f32_16x16x32_bf16 v[60:63], v[148:151], a[48:51], v[60:63]
s_waitcnt vmcnt(19)
v_mfma_f32_16x16x32_bf16 v[32:35], v[152:155], a[24:27], v[32:35]
v_mfma_f32_16x16x32_bf16 v[36:39], v[152:155], a[28:31], v[36:39]
v_mfma_f32_16x16x32_bf16 v[40:43], v[152:155], a[32:35], v[40:43]
v_mfma_f32_16x16x32_bf16 v[44:47], v[152:155], a[36:39], v[44:47]
v_mfma_f32_16x16x32_bf16 v[48:51], v[152:155], a[40:43], v[48:51]
v_mfma_f32_16x16x32_bf16 v[52:55], v[152:155], a[44:47], v[52:55]
v_mfma_f32_16x16x32_bf16 v[56:59], v[152:155], a[48:51], v[56:59]
v_mfma_f32_16x16x32_bf16 v[60:63], v[152:155], a[52:55], v[60:63]
s_waitcnt vmcnt(17)
s_waitcnt lgkmcnt(0)
s_cmp_eq_u32 s52, 7
s_cbranch_scc1 LM_last
v_mfma_f32_16x16x32_bf16 v[64:67], v[160:163], a[60:63], v[64:67]
ds_read_b128 v[192:195], v205 offset:512
ds_read_b128 v[196:199], v206 offset:0
v_mfma_f32_16x16x32_bf16 v[64:67], v[164:167], a[64:67], v[64:67]
ds_read_b32 v230, v207 offset:512
ds_read_b32 v231, v207 offset:64
v_mfma_f32_16x16x32_bf16 v[68:71], v[160:163], a[64:67], v[68:71]
ds_read_b128 a[0:3], v204 offset:0
v_mfma_f32_16x16x32_bf16 v[68:71], v[164:167], a[68:71], v[68:71]
v_mfma_f32_16x16x32_bf16 v[72:75], v[160:163], a[68:71], v[72:75]
v_mfma_f32_16x16x32_bf16 v[72:75], v[164:167], a[72:75], v[72:75]
ds_read_b128 a[4:7], v204 offset:64
v_mfma_f32_16x16x32_bf16 v[76:79], v[160:163], a[72:75], v[76:79]
v_mfma_f32_16x16x32_bf16 v[76:79], v[164:167], a[76:79], v[76:79]
s_waitcnt lgkmcnt(4)
v_lshlrev_b32 v200, 16, v192
v_mfma_f32_16x16x32_bf16 v[80:83], v[160:163], a[76:79], v[80:83]
ds_read_b128 a[8:11], v204 offset:128
v_lshlrev_b32 v201, 16, v196
v_mfma_f32_16x16x32_bf16 v[80:83], v[164:167], a[80:83], v[80:83]
v_and_b32 v202, s54, v192
v_and_b32 v203, s54, v196
v_mfma_f32_16x16x32_bf16 v[84:87], v[160:163], a[80:83], v[84:87]
v_sub_f32 v200, v200, v201
v_sub_f32 v202, v202, v203
v_mfma_f32_16x16x32_bf16 v[84:87], v[164:167], a[84:87], v[84:87]
v_cvt_pk_bf16_f32 v192, v200, v202
v_lshlrev_b32 v200, 16, v193
v_mfma_f32_16x16x32_bf16 v[88:91], v[160:163], a[84:87], v[88:91]
ds_read_b128 a[12:15], v204 offset:192
v_lshlrev_b32 v201, 16, v197
v_mfma_f32_16x16x32_bf16 v[88:91], v[164:167], a[88:91], v[88:91]
v_and_b32 v202, s54, v193
v_and_b32 v203, s54, v197
v_mfma_f32_16x16x32_bf16 v[92:95], v[160:163], a[88:91], v[92:95]
v_sub_f32 v200, v200, v201
v_sub_f32 v202, v202, v203
v_mfma_f32_16x16x32_bf16 v[92:95], v[164:167], a[92:95], v[92:95]
s_waitcnt vmcnt(15)
v_cvt_pk_bf16_f32 v193, v200, v202
v_mfma_f32_16x16x32_bf16 v[64:67], v[168:171], a[68:71], v[64:67]
ds_read_b128 a[16:19], v204 offset:256
v_lshlrev_b32 v200, 16, v194
v_mfma_f32_16x16x32_bf16 v[64:67], v[172:175], a[72:75], v[64:67]
buffer_load_dwordx4 v[120:123], v213, s[24:27], s51 offen offset:2048 sc1
v_mfma_f32_16x16x32_bf16 v[68:71], v[168:171], a[72:75], v[68:71]
ds_read_b128 a[20:23], v204 offset:320
v_lshlrev_b32 v201, 16, v198
v_mfma_f32_16x16x32_bf16 v[68:71], v[172:175], a[76:79], v[68:71]
v_and_b32 v202, s54, v194
v_and_b32 v203, s54, v198
v_mfma_f32_16x16x32_bf16 v[72:75], v[168:171], a[76:79], v[72:75]
v_sub_f32 v200, v200, v201
v_sub_f32 v202, v202, v203
v_mfma_f32_16x16x32_bf16 v[72:75], v[172:175], a[80:83], v[72:75]
buffer_load_dwordx4 v[124:127], v213, s[24:27], s51 offen offset:3072 sc1
v_mfma_f32_16x16x32_bf16 v[76:79], v[168:171], a[80:83], v[76:79]
ds_read_b128 a[24:27], v204 offset:384
v_cvt_pk_bf16_f32 v194, v200, v202
v_mfma_f32_16x16x32_bf16 v[76:79], v[172:175], a[84:87], v[76:79]
v_lshlrev_b32 v200, 16, v195
v_lshlrev_b32 v201, 16, v199
v_mfma_f32_16x16x32_bf16 v[80:83], v[168:171], a[84:87], v[80:83]
s_add_u32 s51, s51, 4096
v_and_b32 v202, s54, v195
v_mfma_f32_16x16x32_bf16 v[80:83], v[172:175], a[88:91], v[80:83]
buffer_load_dwordx4 v[128:131], v213, s[24:27], s51 offen offset:0 sc1
v_mfma_f32_16x16x32_bf16 v[84:87], v[168:171], a[88:91], v[84:87]
ds_read_b128 a[28:31], v204 offset:448
v_and_b32 v203, s54, v199
v_mfma_f32_16x16x32_bf16 v[84:87], v[172:175], a[92:95], v[84:87]
v_sub_f32 v200, v200, v201
v_sub_f32 v202, v202, v203
v_mfma_f32_16x16x32_bf16 v[88:91], v[168:171], a[92:95], v[88:91]
ds_read_b128 a[32:35], v224 offset:0
v_cvt_pk_bf16_f32 v195, v200, v202
v_mfma_f32_16x16x32_bf16 v[88:91], v[172:175], a[96:99], v[88:91]
buffer_load_dwordx4 v[132:135], v213, s[24:27], s51 offen offset:1024 sc1
v_mfma_f32_16x16x32_bf16 v[92:95], v[168:171], a[96:99], v[92:95]
ds_write_b128 v205, v[192:195] offset:1024
s_waitcnt lgkmcnt(10)
v_mfma_f32_16x16x32_bf16 v[92:95], v[172:175], a[100:103], v[92:95]
s_waitcnt vmcnt(17)
v_mfma_f32_16x16x32_bf16 v[64:67], v[176:179], a[76:79], v[64:67]
ds_read_b128 a[36:39], v224 offset:64
v_mfma_f32_16x16x32_bf16 v[64:67], v[180:183], a[80:83], v[64:67]
buffer_load_dwordx4 v[136:139], v213, s[24:27], s51 offen offset:2048 sc1
v_mfma_f32_16x16x32_bf16 v[68:71], v[176:179], a[80:83], v[68:71]
v_lshlrev_b32 v200, 16, v230
v_mfma_f32_16x16x32_bf16 v[68:71], v[180:183], a[84:87], v[68:71]
ds_read_b128 a[40:43], v224 offset:128
v_mfma_f32_16x16x32_bf16 v[72:75], v[176:179], a[84:87], v[72:75]
v_lshlrev_b32 v201, 16, v231
v_mfma_f32_16x16x32_bf16 v[72:75], v[180:183], a[88:91], v[72:75]
buffer_load_dwordx4 v[140:143], v213, s[24:27], s51 offen offset:3072 sc1
v_mfma_f32_16x16x32_bf16 v[76:79], v[176:179], a[88:91], v[76:79]
ds_read_b128 a[44:47], v224 offset:192
v_mfma_f32_16x16x32_bf16 v[76:79], v[180:183], a[92:95], v[76:79]
v_and_b32 v202, s54, v230
v_mfma_f32_16x16x32_bf16 v[80:83], v[176:179], a[92:95], v[80:83]
s_add_u32 s51, s51, 4096
v_mfma_f32_16x16x32_bf16 v[80:83], v[180:183], a[96:99], v[80:83]
buffer_load_dwordx4 v[144:147], v213, s[24:27], s51 offen offset:0 sc1
v_mfma_f32_16x16x32_bf16 v[84:87], v[176:179], a[96:99], v[84:87]
ds_read_b128 a[48:51], v224 offset:256
v_mfma_f32_16x16x32_bf16 v[84:87], v[180:183], a[100:103], v[84:87]
v_and_b32 v203, s54, v231
v_mfma_f32_16x16x32_bf16 v[88:91], v[176:179], a[100:103], v[88:91]
v_sub_f32 v200, v200, v201
v_mfma_f32_16x16x32_bf16 v[88:91], v[180:183], a[104:107], v[88:91]
buffer_load_dwordx4 v[148:151], v213, s[24:27], s51 offen offset:1024 sc1
v_mfma_f32_16x16x32_bf16 v[92:95], v[176:179], a[104:107], v[92:95]
ds_read_b128 a[52:55], v224 offset:320
v_mfma_f32_16x16x32_bf16 v[92:95], v[180:183], a[108:111], v[92:95]
s_waitcnt vmcnt(19)
v_mfma_f32_16x16x32_bf16 v[64:67], v[184:187], a[84:87], v[64:67]
ds_read_b128 a[56:59], v224 offset:384
v_mfma_f32_16x16x32_bf16 v[64:67], v[188:191], a[88:91], v[64:67]
buffer_load_dwordx4 v[152:155], v213, s[24:27], s51 offen offset:2048 sc1
v_mfma_f32_16x16x32_bf16 v[68:71], v[184:187], a[88:91], v[68:71]
v_sub_f32 v202, v202, v203
v_mfma_f32_16x16x32_bf16 v[68:71], v[188:191], a[92:95], v[68:71]
v_cvt_pk_bf16_f32 v230, v200, v202
v_mfma_f32_16x16x32_bf16 v[72:75], v[184:187], a[92:95], v[72:75]
ds_write_b32 v207, v230 offset:1024
v_mfma_f32_16x16x32_bf16 v[72:75], v[188:191], a[96:99], v[72:75]
buffer_load_dwordx4 v[156:159], v213, s[24:27], s51 offen offset:3072 sc1
v_mfma_f32_16x16x32_bf16 v[76:79], v[184:187], a[96:99], v[76:79]
v_mfma_f32_16x16x32_bf16 v[76:79], v[188:191], a[100:103], v[76:79]
v_mfma_f32_16x16x32_bf16 v[80:83], v[184:187], a[100:103], v[80:83]
s_add_u32 s51, s51, 4096
v_mfma_f32_16x16x32_bf16 v[80:83], v[188:191], a[104:107], v[80:83]
buffer_load_dwordx4 v[160:163], v213, s[24:27], s51 offen offset:0 sc1
v_mfma_f32_16x16x32_bf16 v[84:87], v[184:187], a[104:107], v[84:87]
s_add_u32 s49, s49, 64
v_mfma_f32_16x16x32_bf16 v[84:87], v[188:191], a[108:111], v[84:87]
s_add_u32 s50, s50, 64
v_mfma_f32_16x16x32_bf16 v[88:91], v[184:187], a[108:111], v[88:91]
s_add_u32 s52, s52, 1
s_cmp_eq_u32 s52, 7
s_cselect_b32 s22, 0, s22
v_mfma_f32_16x16x32_bf16 v[88:91], v[188:191], a[112:115], v[88:91]
buffer_load_dwordx4 v[164:167], v213, s[24:27], s51 offen offset:1024 sc1
v_mfma_f32_16x16x32_bf16 v[92:95], v[184:187], a[112:115], v[92:95]
v_mfma_f32_16x16x32_bf16 v[92:95], v[188:191], a[116:119], v[92:95]
s_waitcnt vmcnt(21)
s_waitcnt lgkmcnt(1)
s_branch LM_loop
.p2align 6
LM_last:
v_mfma_f32_16x16x32_bf16 v[64:67], v[160:163], a[60:63], v[64:67]
v_mov_b32_dpp v240, v0 row_shl:1 row_mask:0xf bank_mask:0xf bound_ctrl:0
v_mov_b32 v248, 0
v_and_b32 v219, 15, v232
v_mfma_f32_16x16x32_bf16 v[64:67], v[164:167], a[64:67], v[64:67]
v_mov_b32_dpp v241, v1 row_shl:1 row_mask:0xf bank_mask:0xf bound_ctrl:0
v_mov_b32 v249, 0
v_bfe_u32 v220, v232, 4, 2
v_mfma_f32_16x16x32_bf16 v[68:71], v[160:163], a[64:67], v[68:71]
v_mov_b32_dpp v242, v2 row_shl:1 row_mask:0xf bank_mask:0xf bound_ctrl:0
v_mov_b32 v250, 0
s_mov_b32 s61, 0x3b808081
v_mfma_f32_16x16x32_bf16 v[68:71], v[164:167], a[68:71], v[68:71]
v_mov_b32_dpp v243, v3 row_shl:1 row_mask:0xf bank_mask:0xf bound_ctrl:0
v_mov_b32 v251, 0
s_lshl_b32 s56, s46, 7
v_mfma_f32_16x16x32_bf16 v[72:75], v[160:163], a[68:71], v[72:75]
v_mov_b32 v252, 0
v_mfma_f32_16x16x32_bf16 v[72:75], v[164:167], a[72:75], v[72:75]
v_mov_b32 v253, 0
v_lshlrev_b32 v221, 3, v220
v_mfma_f32_16x16x32_bf16 v[76:79], v[160:163], a[72:75], v[76:79]
v_mov_b32 v254, 0
v_lshlrev_b32 v223, 5, v220
v_mfma_f32_16x16x32_bf16 v[76:79], v[164:167], a[76:79], v[76:79]
v_mov_b32 v255, 0
s_lshl_b32 s62, s45, 7
v_mfma_f32_16x16x32_bf16 v[80:83], v[160:163], a[76:79], v[80:83]
v_mfma_f32_16x16x32_bf16 v[80:83], v[164:167], a[80:83], v[80:83]
v_add_f32 v64, v64, v4
v_add_f32 v65, v65, v5
v_mfma_f32_16x16x32_bf16 v[84:87], v[160:163], a[80:83], v[84:87]
v_add_f32 v66, v66, v6
v_add_f32 v67, v67, v7
v_mfma_f32_16x16x32_bf16 v[84:87], v[164:167], a[84:87], v[84:87]
v_add_f32 v68, v68, v8
v_add_f32 v69, v69, v9
v_mfma_f32_16x16x32_bf16 v[88:91], v[160:163], a[84:87], v[88:91]
v_add_f32 v70, v70, v10
v_add_f32 v71, v71, v11
s_cmp_eq_u32 s45, 31
s_cselect_b32 s61, 0x3c4ccccd, s61
s_cselect_b32 s60, 5, 16
v_mfma_f32_16x16x32_bf16 v[88:91], v[164:167], a[88:91], v[88:91]
v_add_f32 v72, v72, v12
v_add_f32 v73, v73, v13
v_mfma_f32_16x16x32_bf16 v[92:95], v[160:163], a[88:91], v[92:95]
v_add_f32 v74, v74, v14
v_add_f32 v75, v75, v15
v_mfma_f32_16x16x32_bf16 v[92:95], v[164:167], a[92:95], v[92:95]
s_waitcnt vmcnt(15)
v_add_f32 v76, v76, v16
v_add_f32 v77, v77, v17
v_mfma_f32_16x16x32_bf16 v[64:67], v[168:171], a[68:71], v[64:67]
v_add_f32 v78, v78, v18
v_add_f32 v79, v79, v19
v_mfma_f32_16x16x32_bf16 v[64:67], v[172:175], a[72:75], v[64:67]
v_add_f32 v80, v80, v20
v_add_f32 v81, v81, v21
v_mfma_f32_16x16x32_bf16 v[68:71], v[168:171], a[72:75], v[68:71]
v_add_f32 v82, v82, v22
v_add_f32 v83, v83, v23
v_cmp_gt_u32 s[64:65], s60, v219
v_mfma_f32_16x16x32_bf16 v[68:71], v[172:175], a[76:79], v[68:71]
v_add_f32 v84, v84, v24
v_add_f32 v85, v85, v25
v_mfma_f32_16x16x32_bf16 v[72:75], v[168:171], a[76:79], v[72:75]
v_add_f32 v86, v86, v26
v_add_f32 v87, v87, v27
v_cmp_ne_u32 s[66:67], 15, v219
v_mfma_f32_16x16x32_bf16 v[72:75], v[172:175], a[80:83], v[72:75]
v_add_f32 v88, v88, v28
v_add_f32 v89, v89, v29
v_mfma_f32_16x16x32_bf16 v[76:79], v[168:171], a[80:83], v[76:79]
v_add_f32 v90, v90, v30
v_add_f32 v91, v91, v31
s_mov_b32 s58, 0x00010001
s_mov_b32 s59, 0x00010001
v_mfma_f32_16x16x32_bf16 v[76:79], v[172:175], a[84:87], v[76:79]
v_add_f32 v92, v92, v240
v_add_f32 v93, v93, v241
v_mfma_f32_16x16x32_bf16 v[80:83], v[168:171], a[84:87], v[80:83]
v_add_f32 v94, v94, v242
v_add_f32 v95, v95, v243
v_mfma_f32_16x16x32_bf16 v[80:83], v[172:175], a[88:91], v[80:83]
v_add_f32 v64, v64, v32
v_add_f32 v65, v65, v33
v_mfma_f32_16x16x32_bf16 v[84:87], v[168:171], a[88:91], v[84:87]
v_add_f32 v66, v66, v34
v_add_f32 v67, v67, v35
v_mfma_f32_16x16x32_bf16 v[84:87], v[172:175], a[92:95], v[84:87]
v_add_f32 v68, v68, v36
v_add_f32 v69, v69, v37
v_mfma_f32_16x16x32_bf16 v[88:91], v[168:171], a[92:95], v[88:91]
v_add_f32 v70, v70, v38
v_add_f32 v71, v71, v39
v_mfma_f32_16x16x32_bf16 v[88:91], v[172:175], a[96:99], v[88:91]
v_add_f32 v72, v72, v40
v_add_f32 v73, v73, v41
v_mfma_f32_16x16x32_bf16 v[92:95], v[168:171], a[96:99], v[92:95]
v_add_f32 v74, v74, v42
v_add_f32 v75, v75, v43
v_mfma_f32_16x16x32_bf16 v[92:95], v[172:175], a[100:103], v[92:95]
s_waitcnt vmcnt(13)
v_add_f32 v76, v76, v44
v_add_f32 v77, v77, v45
v_mfma_f32_16x16x32_bf16 v[64:67], v[176:179], a[76:79], v[64:67]
v_add_f32 v78, v78, v46
v_add_f32 v79, v79, v47
v_mfma_f32_16x16x32_bf16 v[64:67], v[180:183], a[80:83], v[64:67]
v_add_f32 v80, v80, v48
v_add_f32 v81, v81, v49
v_mfma_f32_16x16x32_bf16 v[68:71], v[176:179], a[80:83], v[68:71]
v_add_f32 v82, v82, v50
v_add_f32 v83, v83, v51
v_mfma_f32_16x16x32_bf16 v[68:71], v[180:183], a[84:87], v[68:71]
v_add_f32 v84, v84, v52
v_add_f32 v85, v85, v53
v_mfma_f32_16x16x32_bf16 v[72:75], v[176:179], a[84:87], v[72:75]
v_add_f32 v86, v86, v54
v_add_f32 v87, v87, v55
v_mfma_f32_16x16x32_bf16 v[72:75], v[180:183], a[88:91], v[72:75]
v_add_f32 v88, v88, v56
v_add_f32 v89, v89, v57
v_mfma_f32_16x16x32_bf16 v[76:79], v[176:179], a[88:91], v[76:79]
v_add_f32 v90, v90, v58
v_add_f32 v91, v91, v59
v_mfma_f32_16x16x32_bf16 v[76:79], v[180:183], a[92:95], v[76:79]
v_add_f32 v92, v92, v60
v_add_f32 v93, v93, v61
v_mfma_f32_16x16x32_bf16 v[80:83], v[176:179], a[92:95], v[80:83]
v_add_f32 v94, v94, v62
v_add_f32 v95, v95, v63
v_mfma_f32_16x16x32_bf16 v[80:83], v[180:183], a[96:99], v[80:83]
v_add_f32 v32, v32, v0
v_add_f32 v33, v33, v1
v_mfma_f32_16x16x32_bf16 v[84:87], v[176:179], a[96:99], v[84:87]
v_add_f32 v34, v34, v2
v_add_f32 v35, v35, v3
v_mfma_f32_16x16x32_bf16 v[84:87], v[180:183], a[100:103], v[84:87]
v_add_f32 v36, v36, v4
v_add_f32 v37, v37, v5
v_mfma_f32_16x16x32_bf16 v[88:91], v[176:179], a[100:103], v[88:91]
v_add_f32 v38, v38, v6
v_add_f32 v39, v39, v7
v_mfma_f32_16x16x32_bf16 v[88:91], v[180:183], a[104:107], v[88:91]
v_add_f32 v40, v40, v8
v_add_f32 v41, v41, v9
v_mfma_f32_16x16x32_bf16 v[92:95], v[176:179], a[104:107], v[92:95]
v_add_f32 v42, v42, v10
v_add_f32 v43, v43, v11
v_mfma_f32_16x16x32_bf16 v[92:95], v[180:183], a[108:111], v[92:95]
s_waitcnt vmcnt(11)
v_add_f32 v44, v44, v12
v_add_f32 v45, v45, v13
v_mfma_f32_16x16x32_bf16 v[64:67], v[184:187], a[84:87], v[64:67]
v_add_f32 v46, v46, v14
v_add_f32 v47, v47, v15
v_mfma_f32_16x16x32_bf16 v[64:67], v[188:191], a[88:91], v[64:67]
v_add_f32 v48, v48, v16
v_add_f32 v49, v49, v17
v_mfma_f32_16x16x32_bf16 v[68:71], v[184:187], a[88:91], v[68:71]
v_add_f32 v50, v50, v18
v_add_f32 v51, v51, v19
v_mfma_f32_16x16x32_bf16 v[68:71], v[188:191], a[92:95], v[68:71]
v_add_f32 v52, v52, v20
v_add_f32 v53, v53, v21
v_mfma_f32_16x16x32_bf16 v[72:75], v[184:187], a[92:95], v[72:75]
v_add_f32 v54, v54, v22
v_add_f32 v55, v55, v23
v_mfma_f32_16x16x32_bf16 v[72:75], v[188:191], a[96:99], v[72:75]
v_add_f32 v56, v56, v24
v_add_f32 v57, v57, v25
v_mfma_f32_16x16x32_bf16 v[76:79], v[184:187], a[96:99], v[76:79]
v_add_f32 v58, v58, v26
v_add_f32 v59, v59, v27
v_mfma_f32_16x16x32_bf16 v[76:79], v[188:191], a[100:103], v[76:79]
v_add_f32 v60, v60, v28
v_add_f32 v61, v61, v29
v_mfma_f32_16x16x32_bf16 v[80:83], v[184:187], a[100:103], v[80:83]
v_add_f32 v62, v62, v30
v_add_f32 v63, v63, v31
v_mfma_f32_16x16x32_bf16 v[80:83], v[188:191], a[104:107], v[80:83]
v_mfma_f32_16x16x32_bf16 v[84:87], v[184:187], a[104:107], v[84:87]
v_mov_b32_dpp v244, v32 row_newbcast:0 row_mask:0xf bank_mask:0xf
v_mfma_f32_16x16x32_bf16 v[84:87], v[188:191], a[108:111], v[84:87]
v_mov_b32_dpp v245, v33 row_newbcast:0 row_mask:0xf bank_mask:0xf
v_mfma_f32_16x16x32_bf16 v[88:91], v[184:187], a[108:111], v[88:91]
v_mov_b32_dpp v246, v34 row_newbcast:0 row_mask:0xf bank_mask:0xf
v_mfma_f32_16x16x32_bf16 v[88:91], v[188:191], a[112:115], v[88:91]
v_mov_b32_dpp v247, v35 row_newbcast:0 row_mask:0xf bank_mask:0xf
v_mfma_f32_16x16x32_bf16 v[92:95], v[184:187], a[112:115], v[92:95]
v_mfma_f32_16x16x32_bf16 v[92:95], v[188:191], a[116:119], v[92:95]
v_pk_add_f32 v[32:33], v[32:33], v[244:245] neg_lo:[0,1] neg_hi:[0,1]
v_pk_add_f32 v[34:35], v[34:35], v[246:247] neg_lo:[0,1] neg_hi:[0,1]
v_pk_add_f32 v[248:249], v[248:249], v[32:33]
v_pk_add_f32 v[250:251], v[250:251], v[34:35]
v_pk_fma_f32 v[252:253], v[32:33], v[32:33], v[252:253]
v_pk_fma_f32 v[254:255], v[34:35], v[34:35], v[254:255]
v_pk_add_f32 v[36:37], v[36:37], v[244:245] neg_lo:[0,1] neg_hi:[0,1]
v_pk_add_f32 v[38:39], v[38:39], v[246:247] neg_lo:[0,1] neg_hi:[0,1]
v_pk_add_f32 v[248:249], v[248:249], v[36:37]
v_pk_add_f32 v[250:251], v[250:251], v[38:39]
v_pk_fma_f32 v[252:253], v[36:37], v[36:37], v[252:253]
v_pk_fma_f32 v[254:255], v[38:39], v[38:39], v[254:255]
v_pk_add_f32 v[40:41], v[40:41], v[244:245] neg_lo:[0,1] neg_hi:[0,1]
v_pk_add_f32 v[42:43], v[42:43], v[246:247] neg_lo:[0,1] neg_hi:[0,1]
v_pk_add_f32 v[248:249], v[248:249], v[40:41]
v_pk_add_f32 v[250:251], v[250:251], v[42:43]
v_pk_fma_f32 v[252:253], v[40:41], v[40:41], v[252:253]
v_pk_fma_f32 v[254:255], v[42:43], v[42:43], v[254:255]
v_pk_add_f32 v[44:45], v[44:45], v[244:245] neg_lo:[0,1] neg_hi:[0,1]
v_pk_add_f32 v[46:47], v[46:47], v[246:247] neg_lo:[0,1] neg_hi:[0,1]
v_pk_add_f32 v[248:249], v[248:249], v[44:45]
v_pk_add_f32 v[250:251], v[250:251], v[46:47]
v_pk_fma_f32 v[252:253], v[44:45], v[44:45], v[252:253]
v_pk_fma_f32 v[254:255], v[46:47], v[46:47], v[254:255]
v_pk_add_f32 v[48:49], v[48:49], v[244:245] neg_lo:[0,1] neg_hi:[0,1]
v_pk_add_f32 v[50:51], v[50:51], v[246:247] neg_lo:[0,1] neg_hi:[0,1]
v_pk_add_f32 v[248:249], v[248:249], v[48:49]
v_pk_add_f32 v[250:251], v[250:251], v[50:51]
v_pk_fma_f32 v[252:253], v[48:49], v[48:49], v[252:253]
v_pk_fma_f32 v[254:255], v[50:51], v[50:51], v[254:255]
v_pk_add_f32 v[52:53], v[52:53], v[244:245] neg_lo:[0,1] neg_hi:[0,1]
v_pk_add_f32 v[54:55], v[54:55], v[246:247] neg_lo:[0,1] neg_hi:[0,1]
v_pk_add_f32 v[248:249], v[248:249], v[52:53]
v_pk_add_f32 v[250:251], v[250:251], v[54:55]
v_pk_fma_f32 v[252:253], v[52:53], v[52:53], v[252:253]
v_pk_fma_f32 v[254:255], v[54:55], v[54:55], v[254:255]
v_pk_add_f32 v[56:57], v[56:57], v[244:245] neg_lo:[0,1] neg_hi:[0,1]
v_pk_add_f32 v[58:59], v[58:59], v[246:247] neg_lo:[0,1] neg_hi:[0,1]
v_pk_add_f32 v[248:249], v[248:249], v[56:57]
v_pk_add_f32 v[250:251], v[250:251], v[58:59]
v_pk_fma_f32 v[252:253], v[56:57], v[56:57], v[252:253]
v_pk_fma_f32 v[254:255], v[58:59], v[58:59], v[254:255]
v_pk_add_f32 v[60:61], v[60:61], v[244:245] neg_lo:[0,1] neg_hi:[0,1]
v_pk_add_f32 v[62:63], v[62:63], v[246:247] neg_lo:[0,1] neg_hi:[0,1]
v_pk_add_f32 v[248:249], v[248:249], v[60:61]
v_pk_add_f32 v[250:251], v[250:251], v[62:63]
v_pk_fma_f32 v[252:253], v[60:61], v[60:61], v[252:253]
v_pk_fma_f32 v[254:255], v[62:63], v[62:63], v[254:255]
v_pk_add_f32 v[64:65], v[64:65], v[244:245] neg_lo:[0,1] neg_hi:[0,1]
v_pk_add_f32 v[66:67], v[66:67], v[246:247] neg_lo:[0,1] neg_hi:[0,1]
v_pk_add_f32 v[248:249], v[248:249], v[64:65]
v_pk_add_f32 v[250:251], v[250:251], v[66:67]
v_pk_fma_f32 v[252:253], v[64:65], v[64:65], v[252:253]
v_pk_fma_f32 v[254:255], v[66:67], v[66:67], v[254:255]
v_pk_add_f32 v[68:69], v[68:69], v[244:245] neg_lo:[0,1] neg_hi:[0,1]
v_pk_add_f32 v[70:71], v[70:71], v[246:247] neg_lo:[0,1] neg_hi:[0,1]
v_pk_add_f32 v[248:249], v[248:249], v[68:69]
v_pk_add_f32 v[250:251], v[250:251], v[70:71]
v_pk_fma_f32 v[252:253], v[68:69], v[68:69], v[252:253]
v_pk_fma_f32 v[254:255], v[70:71], v[70:71], v[254:255]
v_pk_add_f32 v[72:73], v[72:73], v[244:245] neg_lo:[0,1] neg_hi:[0,1]
v_pk_add_f32 v[74:75], v[74:75], v[246:247] neg_lo:[0,1] neg_hi:[0,1]
v_pk_add_f32 v[248:249], v[248:249], v[72:73]
v_pk_add_f32 v[250:251], v[250:251], v[74:75]
v_pk_fma_f32 v[252:253], v[72:73], v[72:73], v[252:253]
v_pk_fma_f32 v[254:255], v[74:75], v[74:75], v[254:255]
v_pk_add_f32 v[76:77], v[76:77], v[244:245] neg_lo:[0,1] neg_hi:[0,1]
v_pk_add_f32 v[78:79], v[78:79], v[246:247] neg_lo:[0,1] neg_hi:[0,1]
v_pk_add_f32 v[248:249], v[248:249], v[76:77]
v_pk_add_f32 v[250:251], v[250:251], v[78:79]
v_pk_fma_f32 v[252:253], v[76:77], v[76:77], v[252:253]
v_pk_fma_f32 v[254:255], v[78:79], v[78:79], v[254:255]
v_pk_add_f32 v[80:81], v[80:81], v[244:245] neg_lo:[0,1] neg_hi:[0,1]
v_pk_add_f32 v[82:83], v[82:83], v[246:247] neg_lo:[0,1] neg_hi:[0,1]
v_pk_add_f32 v[248:249], v[248:249], v[80:81]
v_pk_add_f32 v[250:251], v[250:251], v[82:83]
v_pk_fma_f32 v[252:253], v[80:81], v[80:81], v[252:253]
v_pk_fma_f32 v[254:255], v[82:83], v[82:83], v[254:255]
v_pk_add_f32 v[84:85], v[84:85], v[244:245] neg_lo:[0,1] neg_hi:[0,1]
v_pk_add_f32 v[86:87], v[86:87], v[246:247] neg_lo:[0,1] neg_hi:[0,1]
v_pk_add_f32 v[248:249], v[248:249], v[84:85]
v_pk_add_f32 v[250:251], v[250:251], v[86:87]
v_pk_fma_f32 v[252:253], v[84:85], v[84:85], v[252:253]
v_pk_fma_f32 v[254:255], v[86:87], v[86:87], v[254:255]
v_pk_add_f32 v[88:89], v[88:89], v[244:245] neg_lo:[0,1] neg_hi:[0,1]
v_pk_add_f32 v[90:91], v[90:91], v[246:247] neg_lo:[0,1] neg_hi:[0,1]
v_pk_add_f32 v[248:249], v[248:249], v[88:89]
v_pk_add_f32 v[250:251], v[250:251], v[90:91]
v_pk_fma_f32 v[252:253], v[88:89], v[88:89], v[252:253]
v_pk_fma_f32 v[254:255], v[90:91], v[90:91], v[254:255]
v_pk_add_f32 v[92:93], v[92:93], v[244:245] neg_lo:[0,1] neg_hi:[0,1]
v_pk_add_f32 v[94:95], v[94:95], v[246:247] neg_lo:[0,1] neg_hi:[0,1]
s_mov_b64 exec, s[66:67]
v_pk_add_f32 v[248:249], v[248:249], v[92:93]
v_pk_add_f32 v[250:251], v[250:251], v[94:95]
v_pk_fma_f32 v[252:253], v[92:93], v[92:93], v[252:253]
v_pk_fma_f32 v[254:255], v[94:95], v[94:95], v[254:255]
s_mov_b64 exec, -1
v_cndmask_b32 v248, 0, v248, s[64:65]
v_cndmask_b32 v249, 0, v249, s[64:65]
v_cndmask_b32 v250, 0, v250, s[64:65]
v_cndmask_b32 v251, 0, v251, s[64:65]
v_cndmask_b32 v252, 0, v252, s[64:65]
v_cndmask_b32 v253, 0, v253, s[64:65]
v_cndmask_b32 v254, 0, v254, s[64:65]
v_cndmask_b32 v255, 0, v255, s[64:65]
v_add_f32_dpp v248, v248, v248 row_ror:8 row_mask:0xf bank_mask:0xf
v_add_f32_dpp v249, v249, v249 row_ror:8 row_mask:0xf bank_mask:0xf
v_add_f32_dpp v250, v250, v250 row_ror:8 row_mask:0xf bank_mask:0xf
v_add_f32_dpp v251, v251, v251 row_ror:8 row_mask:0xf bank_mask:0xf
v_add_f32_dpp v252, v252, v252 row_ror:8 row_mask:0xf bank_mask:0xf
v_add_f32_dpp v253, v253, v253 row_ror:8 row_mask:0xf bank_mask:0xf
v_add_f32_dpp v254, v254, v254 row_ror:8 row_mask:0xf bank_mask:0xf
v_add_f32_dpp v255, v255, v255 row_ror:8 row_mask:0xf bank_mask:0xf
v_add_f32_dpp v248, v248, v248 row_ror:4 row_mask:0xf bank_mask:0xf
v_add_f32_dpp v249, v249, v249 row_ror:4 row_mask:0xf bank_mask:0xf
v_add_f32_dpp v250, v250, v250 row_ror:4 row_mask:0xf bank_mask:0xf
v_add_f32_dpp v251, v251, v251 row_ror:4 row_mask:0xf bank_mask:0xf
v_add_f32_dpp v252, v252, v252 row_ror:4 row_mask:0xf bank_mask:0xf
v_add_f32_dpp v253, v253, v253 row_ror:4 row_mask:0xf bank_mask:0xf
v_add_f32_dpp v254, v254, v254 row_ror:4 row_mask:0xf bank_mask:0xf
v_add_f32_dpp v255, v255, v255 row_ror:4 row_mask:0xf bank_mask:0xf
v_add_f32_dpp v248, v248, v248 row_ror:2 row_mask:0xf bank_mask:0xf
v_add_f32_dpp v249, v249, v249 row_ror:2 row_mask:0xf bank_mask:0xf
v_add_f32_dpp v250, v250, v250 row_ror:2 row_mask:0xf bank_mask:0xf
v_add_f32_dpp v251, v251, v251 row_ror:2 row_mask:0xf bank_mask:0xf
v_add_f32_dpp v252, v252, v252 row_ror:2 row_mask:0xf bank_mask:0xf
v_add_f32_dpp v253, v253, v253 row_ror:2 row_mask:0xf bank_mask:0xf
v_add_f32_dpp v254, v254, v254 row_ror:2 row_mask:0xf bank_mask:0xf
v_add_f32_dpp v255, v255, v255 row_ror:2 row_mask:0xf bank_mask:0xf
v_add_f32_dpp v248, v248, v248 row_ror:1 row_mask:0xf bank_mask:0xf
v_add_f32_dpp v249, v249, v249 row_ror:1 row_mask:0xf bank_mask:0xf
v_add_f32_dpp v250, v250, v250 row_ror:1 row_mask:0xf bank_mask:0xf
v_add_f32_dpp v251, v251, v251 row_ror:1 row_mask:0xf bank_mask:0xf
v_add_f32_dpp v252, v252, v252 row_ror:1 row_mask:0xf bank_mask:0xf
v_add_f32_dpp v253, v253, v253 row_ror:1 row_mask:0xf bank_mask:0xf
v_add_f32_dpp v254, v254, v254 row_ror:1 row_mask:0xf bank_mask:0xf
v_add_f32_dpp v255, v255, v255 row_ror:1 row_mask:0xf bank_mask:0xf
v_mul_f32 v12, s61, v248
v_mul_f32 v13, s61, v249
v_mul_f32 v14, s61, v250
v_mul_f32 v15, s61, v251
v_fma_f32 v16, -v248, v12, v252
v_fma_f32 v17, -v249, v13, v253
v_fma_f32 v18, -v250, v14, v254
v_fma_f32 v19, -v251, v15, v255
v_add_f32 v12, v12, v244
v_add_f32 v13, v13, v245
v_add_f32 v14, v14, v246
v_add_f32 v15, v15, v247
s_mov_b64 exec, s[58:59]
buffer_store_dwordx4 v[12:15], v223, s[32:35], s62 offen sc1
buffer_store_dwordx4 v[16:19], v223, s[32:35], s62 offen offset:16 sc1
s_mov_b64 exec, -1
v_accvgpr_read_b32 v214, a120
v_accvgpr_read_b32 v215, a121
v_accvgpr_read_b32 v216, a122
v_accvgpr_read_b32 v217, a123
v_lshl_add_u32 v223, v219, 8, v223
s_mov_b32 s63, 0
v_mov_b32 v224, 0x437f0000
v_mov_b32 v225, 0x42a00000
v_cmp_eq_u32 vcc, 15, v219
s_mov_b32 s58, 0x437f0000
s_mov_b32 s59, 0x39035177
v_cndmask_b32 v224, v224, v225, vcc
s_movk_i32 s78, 199
s_mov_b32 s72, 0xbdd2d3e8
s_mov_b32 s73, 0xbdd2d3e8
v_mov_b32 v30, 0xc0135761
v_mov_b32 v31, 0xc0135761
v_mov_b32 v22, 1.0
v_mov_b32 v23, 1.0
v_mul_u32_u24 v28, 2064, v219
v_add_u32 v28, v28, v221
s_lshl_b32 s74, s44, 5
s_add_u32 s74, s74, 54528
v_add_u32 v28, s74, v28
v_and_b32 v24, 63, v232
s_mul_i32 s74, s44, 8256
s_add_u32 s74, s74, 54528
v_lshlrev_b32 v25, 4, v24
v_add_u32 v25, s74, v25
v_lshrrev_b32 v26, 3, v24
v_and_b32 v27, 7, v24
v_lshlrev_b32 v27, 4, v27
v_lshl_add_u32 v27, v26, 9, v27
s_lshl_b32 s75, s44, 6
v_add_u32 v26, s75, v26
s_add_u32 s75, s75, s48
s_lshl_b32 s75, s75, 9
s_add_u32 s75, s75, s56
v_cmp_gt_u32 s[76:77], s78, v26
v_mov_b32 v0, v12
v_sub_f32 v244, v244, v12
v_mov_b32 v1, v13
v_sub_f32 v245, v245, v13
v_mov_b32 v2, v14
v_sub_f32 v246, v246, v14
v_mov_b32 v3, v15
v_sub_f32 v247, v247, v15
v_mov_b32 v29, 0x3727c5ac
v_lshlrev_b32 v240, 16, v214
v_and_b32 v241, s54, v214
v_lshlrev_b32 v242, 16, v215
v_and_b32 v243, s54, v215
v_lshlrev_b32 v248, 16, v216
v_and_b32 v249, s54, v216
v_lshlrev_b32 v250, 16, v217
v_and_b32 v251, s54, v217
LM_poll:
buffer_load_dwordx4 v[96:99], v223, s[32:35], 0 offen offset:0 sc1
buffer_load_dwordx4 v[100:103], v223, s[32:35], 0 offen offset:16 sc1
buffer_load_dwordx4 v[104:107], v223, s[32:35], 0 offen offset:128 sc1
buffer_load_dwordx4 v[108:111], v223, s[32:35], 0 offen offset:144 sc1
s_add_u32 s63, s63, 1
s_waitcnt vmcnt(0)
v_max3_u32 v20, v96, v97, v98
v_max3_u32 v20, v20, v99, v100
v_max3_u32 v20, v20, v101, v102
v_max3_u32 v20, v20, v103, v104
v_max3_u32 v20, v20, v105, v106
v_max3_u32 v20, v20, v107, v108
v_max3_u32 v20, v20, v109, v110
v_max_u32 v20, v20, v111
v_cmp_eq_u32 vcc, -1, v20
s_cmp_ge_u32 s63, 4000000
s_cbranch_scc1 LM_go
s_cbranch_vccnz LM_poll
LM_go:
v_sub_f32 v96, v96, v0
v_sub_f32 v104, v104, v0
v_sub_f32 v97, v97, v1
v_sub_f32 v105, v105, v1
v_sub_f32 v98, v98, v2
v_sub_f32 v106, v106, v2
v_sub_f32 v99, v99, v3
v_sub_f32 v107, v107, v3
v_add_f32 v8, v100, v108
v_mul_f32 v100, s58, v96
v_mul_f32 v108, v224, v104
v_add_f32 v9, v101, v109
v_mul_f32 v101, s58, v97
v_mul_f32 v109, v224, v105
v_add_f32 v10, v102, v110
v_mul_f32 v102, s58, v98
v_mul_f32 v110, v224, v106
v_add_f32 v11, v103, v111
v_mul_f32 v103, s58, v99
v_mul_f32 v111, v224, v107
v_add_f32 v4, v100, v108
v_fmac_f32 v8, v100, v96
v_add_f32 v5, v101, v109
v_fmac_f32 v9, v101, v97
v_add_f32 v6, v102, v110
v_fmac_f32 v10, v102, v98
v_add_f32 v7, v103, v111
v_fmac_f32 v11, v103, v99
v_fmac_f32 v8, v108, v104
v_fmac_f32 v9, v109, v105
v_fmac_f32 v10, v110, v106
v_fmac_f32 v11, v111, v107
v_add_f32_dpp v4, v4, v4 row_ror:8 row_mask:0xf bank_mask:0xf
v_add_f32_dpp v5, v5, v5 row_ror:8 row_mask:0xf bank_mask:0xf
v_add_f32_dpp v6, v6, v6 row_ror:8 row_mask:0xf bank_mask:0xf
v_add_f32_dpp v7, v7, v7 row_ror:8 row_mask:0xf bank_mask:0xf
v_add_f32_dpp v8, v8, v8 row_ror:8 row_mask:0xf bank_mask:0xf
v_add_f32_dpp v9, v9, v9 row_ror:8 row_mask:0xf bank_mask:0xf
v_add_f32_dpp v10, v10, v10 row_ror:8 row_mask:0xf bank_mask:0xf
v_add_f32_dpp v11, v11, v11 row_ror:8 row_mask:0xf bank_mask:0xf
v_add_f32_dpp v4, v4, v4 row_ror:4 row_mask:0xf bank_mask:0xf
v_add_f32_dpp v5, v5, v5 row_ror:4 row_mask:0xf bank_mask:0xf
v_add_f32_dpp v6, v6, v6 row_ror:4 row_mask:0xf bank_mask:0xf
v_add_f32_dpp v7, v7, v7 row_ror:4 row_mask:0xf bank_mask:0xf
v_add_f32_dpp v8, v8, v8 row_ror:4 row_mask:0xf bank_mask:0xf
v_add_f32_dpp v9, v9, v9 row_ror:4 row_mask:0xf bank_mask:0xf
v_add_f32_dpp v10, v10, v10 row_ror:4 row_mask:0xf bank_mask:0xf
v_add_f32_dpp v11, v11, v11 row_ror:4 row_mask:0xf bank_mask:0xf
v_add_f32_dpp v4, v4, v4 row_ror:2 row_mask:0xf bank_mask:0xf
v_add_f32_dpp v5, v5, v5 row_ror:2 row_mask:0xf bank_mask:0xf
v_add_f32_dpp v6, v6, v6 row_ror:2 row_mask:0xf bank_mask:0xf
v_add_f32_dpp v7, v7, v7 row_ror:2 row_mask:0xf bank_mask:0xf
v_add_f32_dpp v8, v8, v8 row_ror:2 row_mask:0xf bank_mask:0xf
v_add_f32_dpp v9, v9, v9 row_ror:2 row_mask:0xf bank_mask:0xf
v_add_f32_dpp v10, v10, v10 row_ror:2 row_mask:0xf bank_mask:0xf
v_add_f32_dpp v11, v11, v11 row_ror:2 row_mask:0xf bank_mask:0xf
v_add_f32_dpp v4, v4, v4 row_ror:1 row_mask:0xf bank_mask:0xf
v_add_f32_dpp v5, v5, v5 row_ror:1 row_mask:0xf bank_mask:0xf
v_add_f32_dpp v6, v6, v6 row_ror:1 row_mask:0xf bank_mask:0xf
v_add_f32_dpp v7, v7, v7 row_ror:1 row_mask:0xf bank_mask:0xf
v_add_f32_dpp v8, v8, v8 row_ror:1 row_mask:0xf bank_mask:0xf
v_add_f32_dpp v9, v9, v9 row_ror:1 row_mask:0xf bank_mask:0xf
v_add_f32_dpp v10, v10, v10 row_ror:1 row_mask:0xf bank_mask:0xf
v_add_f32_dpp v11, v11, v11 row_ror:1 row_mask:0xf bank_mask:0xf
v_mul_f32 v96, s59, v4
v_mul_f32 v97, s59, v5
v_mul_f32 v98, s59, v6
v_mul_f32 v99, s59, v7
v_fma_f32 v8, -v4, v96, v8
v_fma_f32 v9, -v5, v97, v9
v_fma_f32 v10, -v6, v98, v10
v_fma_f32 v11, -v7, v99, v11
v_fma_f32 v8, v8, s59, v29
v_fma_f32 v9, v9, s59, v29
v_fma_f32 v10, v10, s59, v29
v_fma_f32 v11, v11, s59, v29
v_rsq_f32 v8, v8
v_rsq_f32 v9, v9
v_rsq_f32 v10, v10
v_rsq_f32 v11, v11
v_sub_f32 v244, v244, v96
v_sub_f32 v245, v245, v97
v_sub_f32 v246, v246, v98
v_sub_f32 v247, v247, v99
v_mul_f32 v8, v8, v240
v_mul_f32 v9, v9, v241
v_mul_f32 v10, v10, v242
v_mul_f32 v11, v11, v243
v_fmac_f32 v248, v244, v8
v_fmac_f32 v249, v245, v9
v_fmac_f32 v250, v246, v10
v_fmac_f32 v251, v247, v11
v_pk_fma_f32 v[32:33], v[32:33], v[8:9], v[248:249]
v_pk_fma_f32 v[34:35], v[34:35], v[10:11], v[250:251]
v_pk_fma_f32 v[64:65], v[64:65], v[8:9], v[248:249]
v_pk_fma_f32 v[66:67], v[66:67], v[10:11], v[250:251]
v_pk_mul_f32 v[112:113], v[32:33], v[32:33]
v_pk_mul_f32 v[114:115], v[34:35], v[34:35]
v_pk_mul_f32 v[116:117], v[64:65], v[64:65]
v_pk_mul_f32 v[118:119], v[66:67], v[66:67]
v_pk_fma_f32 v[112:113], v[112:113], s[72:73], v[30:31]
v_pk_fma_f32 v[114:115], v[114:115], s[72:73], v[30:31]
v_pk_fma_f32 v[116:117], v[116:117], s[72:73], v[30:31]
v_pk_fma_f32 v[118:119], v[118:119], s[72:73], v[30:31]
v_pk_mul_f32 v[112:113], v[112:113], v[32:33]
v_pk_mul_f32 v[114:115], v[114:115], v[34:35]
v_pk_mul_f32 v[116:117], v[116:117], v[64:65]
v_pk_mul_f32 v[118:119], v[118:119], v[66:67]
v_exp_f32 v112, v112
v_exp_f32 v113, v113
v_exp_f32 v114, v114
v_exp_f32 v115, v115
v_exp_f32 v116, v116
v_exp_f32 v117, v117
v_exp_f32 v118, v118
v_exp_f32 v119, v119
v_pk_add_f32 v[112:113], v[112:113], v[22:23]
v_pk_add_f32 v[114:115], v[114:115], v[22:23]
v_pk_add_f32 v[116:117], v[116:117], v[22:23]
v_pk_add_f32 v[118:119], v[118:119], v[22:23]
v_rcp_f32 v112, v112
v_rcp_f32 v113, v113
v_rcp_f32 v114, v114
v_rcp_f32 v115, v115
v_rcp_f32 v116, v116
v_rcp_f32 v117, v117
v_rcp_f32 v118, v118
v_rcp_f32 v119, v119
v_pk_mul_f32 v[112:113], v[112:113], v[32:33]
v_pk_mul_f32 v[114:115], v[114:115], v[34:35]
v_pk_mul_f32 v[116:117], v[116:117], v[64:65]
v_pk_mul_f32 v[118:119], v[118:119], v[66:67]
v_cvt_pk_bf16_f32 v120, v112, v113
v_cvt_pk_bf16_f32 v121, v114, v115
v_cvt_pk_bf16_f32 v122, v116, v117
v_cvt_pk_bf16_f32 v123, v118, v119
ds_write_b64 v28, v[120:121] offset:0
ds_write_b64 v28, v[122:123] offset:128
v_pk_fma_f32 v[36:37], v[36:37], v[8:9], v[248:249]
v_pk_fma_f32 v[38:39], v[38:39], v[10:11], v[250:251]
v_pk_fma_f32 v[68:69], v[68:69], v[8:9], v[248:249]
v_pk_fma_f32 v[70:71], v[70:71], v[10:11], v[250:251]
v_pk_mul_f32 v[112:113], v[36:37], v[36:37]
v_pk_mul_f32 v[114:115], v[38:39], v[38:39]
v_pk_mul_f32 v[116:117], v[68:69], v[68:69]
v_pk_mul_f32 v[118:119], v[70:71], v[70:71]
v_pk_fma_f32 v[112:113], v[112:113], s[72:73], v[30:31]
v_pk_fma_f32 v[114:115], v[114:115], s[72:73], v[30:31]
v_pk_fma_f32 v[116:117], v[116:117], s[72:73], v[30:31]
v_pk_fma_f32 v[118:119], v[118:119], s[72:73], v[30:31]
v_pk_mul_f32 v[112:113], v[112:113], v[36:37]
v_pk_mul_f32 v[114:115], v[114:115], v[38:39]
v_pk_mul_f32 v[116:117], v[116:117], v[68:69]
v_pk_mul_f32 v[118:119], v[118:119], v[70:71]
v_exp_f32 v112, v112
v_exp_f32 v113, v113
v_exp_f32 v114, v114
v_exp_f32 v115, v115
v_exp_f32 v116, v116
v_exp_f32 v117, v117
v_exp_f32 v118, v118
v_exp_f32 v119, v119
v_pk_add_f32 v[112:113], v[112:113], v[22:23]
v_pk_add_f32 v[114:115], v[114:115], v[22:23]
v_pk_add_f32 v[116:117], v[116:117], v[22:23]
v_pk_add_f32 v[118:119], v[118:119], v[22:23]
v_rcp_f32 v112, v112
v_rcp_f32 v113, v113
v_rcp_f32 v114, v114
v_rcp_f32 v115, v115
v_rcp_f32 v116, v116
v_rcp_f32 v117, v117
v_rcp_f32 v118, v118
v_rcp_f32 v119, v119
v_pk_mul_f32 v[112:113], v[112:113], v[36:37]
v_pk_mul_f32 v[114:115], v[114:115], v[38:39]
v_pk_mul_f32 v[116:117], v[116:117], v[68:69]
v_pk_mul_f32 v[118:119], v[118:119], v[70:71]
v_cvt_pk_bf16_f32 v124, v112, v113
v_cvt_pk_bf16_f32 v125, v114, v115
v_cvt_pk_bf16_f32 v126, v116, v117
v_cvt_pk_bf16_f32 v127, v118, v119
ds_write_b64 v28, v[124:125] offset:256
ds_write_b64 v28, v[126:127] offset:384
v_pk_fma_f32 v[40:41], v[40:41], v[8:9], v[248:249]
v_pk_fma_f32 v[42:43], v[42:43], v[10:11], v[250:251]
v_pk_fma_f32 v[72:73], v[72:73], v[8:9], v[248:249]
v_pk_fma_f32 v[74:75], v[74:75], v[10:11], v[250:251]
v_pk_mul_f32 v[112:113], v[40:41], v[40:41]
v_pk_mul_f32 v[114:115], v[42:43], v[42:43]
v_pk_mul_f32 v[116:117], v[72:73], v[72:73]
v_pk_mul_f32 v[118:119], v[74:75], v[74:75]
v_pk_fma_f32 v[112:113], v[112:113], s[72:73], v[30:31]
v_pk_fma_f32 v[114:115], v[114:115], s[72:73], v[30:31]
v_pk_fma_f32 v[116:117], v[116:117], s[72:73], v[30:31]
v_pk_fma_f32 v[118:119], v[118:119], s[72:73], v[30:31]
v_pk_mul_f32 v[112:113], v[112:113], v[40:41]
v_pk_mul_f32 v[114:115], v[114:115], v[42:43]
v_pk_mul_f32 v[116:117], v[116:117], v[72:73]
v_pk_mul_f32 v[118:119], v[118:119], v[74:75]
v_exp_f32 v112, v112
v_exp_f32 v113, v113
v_exp_f32 v114, v114
v_exp_f32 v115, v115
v_exp_f32 v116, v116
v_exp_f32 v117, v117
v_exp_f32 v118, v118
v_exp_f32 v119, v119
v_pk_add_f32 v[112:113], v[112:113], v[22:23]
v_pk_add_f32 v[114:115], v[114:115], v[22:23]
v_pk_add_f32 v[116:117], v[116:117], v[22:23]
v_pk_add_f32 v[118:119], v[118:119], v[22:23]
v_rcp_f32 v112, v112
v_rcp_f32 v113, v113
v_rcp_f32 v114, v114
v_rcp_f32 v115, v115
v_rcp_f32 v116, v116
v_rcp_f32 v117, v117
v_rcp_f32 v118, v118
v_rcp_f32 v119, v119
v_pk_mul_f32 v[112:113], v[112:113], v[40:41]
v_pk_mul_f32 v[114:115], v[114:115], v[42:43]
v_pk_mul_f32 v[116:117], v[116:117], v[72:73]
v_pk_mul_f32 v[118:119], v[118:119], v[74:75]
v_cvt_pk_bf16_f32 v120, v112, v113
v_cvt_pk_bf16_f32 v121, v114, v115
v_cvt_pk_bf16_f32 v122, v116, v117
v_cvt_pk_bf16_f32 v123, v118, v119
ds_write_b64 v28, v[120:121] offset:512
ds_write_b64 v28, v[122:123] offset:640
v_pk_fma_f32 v[44:45], v[44:45], v[8:9], v[248:249]
v_pk_fma_f32 v[46:47], v[46:47], v[10:11], v[250:251]
v_pk_fma_f32 v[76:77], v[76:77], v[8:9], v[248:249]
v_pk_fma_f32 v[78:79], v[78:79], v[10:11], v[250:251]
v_pk_mul_f32 v[112:113], v[44:45], v[44:45]
v_pk_mul_f32 v[114:115], v[46:47], v[46:47]
v_pk_mul_f32 v[116:117], v[76:77], v[76:77]
v_pk_mul_f32 v[118:119], v[78:79], v[78:79]
v_pk_fma_f32 v[112:113], v[112:113], s[72:73], v[30:31]
v_pk_fma_f32 v[114:115], v[114:115], s[72:73], v[30:31]
v_pk_fma_f32 v[116:117], v[116:117], s[72:73], v[30:31]
v_pk_fma_f32 v[118:119], v[118:119], s[72:73], v[30:31]
v_pk_mul_f32 v[112:113], v[112:113], v[44:45]
v_pk_mul_f32 v[114:115], v[114:115], v[46:47]
v_pk_mul_f32 v[116:117], v[116:117], v[76:77]
v_pk_mul_f32 v[118:119], v[118:119], v[78:79]
v_exp_f32 v112, v112
v_exp_f32 v113, v113
v_exp_f32 v114, v114
v_exp_f32 v115, v115
v_exp_f32 v116, v116
v_exp_f32 v117, v117
v_exp_f32 v118, v118
v_exp_f32 v119, v119
v_pk_add_f32 v[112:113], v[112:113], v[22:23]
v_pk_add_f32 v[114:115], v[114:115], v[22:23]
v_pk_add_f32 v[116:117], v[116:117], v[22:23]
v_pk_add_f32 v[118:119], v[118:119], v[22:23]
v_rcp_f32 v112, v112
v_rcp_f32 v113, v113
v_rcp_f32 v114, v114
v_rcp_f32 v115, v115
v_rcp_f32 v116, v116
v_rcp_f32 v117, v117
v_rcp_f32 v118, v118
v_rcp_f32 v119, v119
v_pk_mul_f32 v[112:113], v[112:113], v[44:45]
v_pk_mul_f32 v[114:115], v[114:115], v[46:47]
v_pk_mul_f32 v[116:117], v[116:117], v[76:77]
v_pk_mul_f32 v[118:119], v[118:119], v[78:79]
v_cvt_pk_bf16_f32 v124, v112, v113
v_cvt_pk_bf16_f32 v125, v114, v115
v_cvt_pk_bf16_f32 v126, v116, v117
v_cvt_pk_bf16_f32 v127, v118, v119
ds_write_b64 v28, v[124:125] offset:768
ds_write_b64 v28, v[126:127] offset:896
v_pk_fma_f32 v[48:49], v[48:49], v[8:9], v[248:249]
v_pk_fma_f32 v[50:51], v[50:51], v[10:11], v[250:251]
v_pk_fma_f32 v[80:81], v[80:81], v[8:9], v[248:249]
v_pk_fma_f32 v[82:83], v[82:83], v[10:11], v[250:251]
v_pk_mul_f32 v[112:113], v[48:49], v[48:49]
v_pk_mul_f32 v[114:115], v[50:51], v[50:51]
v_pk_mul_f32 v[116:117], v[80:81], v[80:81]
v_pk_mul_f32 v[118:119], v[82:83], v[82:83]
s_waitcnt vmcnt(0) lgkmcnt(0)
s_barrier
ds_read_b128 v[128:131], v25 offset:0
ds_read_b128 v[136:139], v25 offset:2064
ds_read_b128 v[144:147], v25 offset:4128
ds_read_b128 v[152:155], v25 offset:6192
v_pk_fma_f32 v[112:113], v[112:113], s[72:73], v[30:31]
v_pk_fma_f32 v[114:115], v[114:115], s[72:73], v[30:31]
v_pk_fma_f32 v[116:117], v[116:117], s[72:73], v[30:31]
v_pk_fma_f32 v[118:119], v[118:119], s[72:73], v[30:31]
v_pk_mul_f32 v[112:113], v[112:113], v[48:49]
v_pk_mul_f32 v[114:115], v[114:115], v[50:51]
v_pk_mul_f32 v[116:117], v[116:117], v[80:81]
v_pk_mul_f32 v[118:119], v[118:119], v[82:83]
v_exp_f32 v112, v112
v_exp_f32 v113, v113
v_exp_f32 v114, v114
v_exp_f32 v115, v115
v_exp_f32 v116, v116
v_exp_f32 v117, v117
v_exp_f32 v118, v118
v_exp_f32 v119, v119
v_pk_add_f32 v[112:113], v[112:113], v[22:23]
v_pk_add_f32 v[114:115], v[114:115], v[22:23]
v_pk_add_f32 v[116:117], v[116:117], v[22:23]
v_pk_add_f32 v[118:119], v[118:119], v[22:23]
v_rcp_f32 v112, v112
v_rcp_f32 v113, v113
v_rcp_f32 v114, v114
v_rcp_f32 v115, v115
v_rcp_f32 v116, v116
v_rcp_f32 v117, v117
v_rcp_f32 v118, v118
v_rcp_f32 v119, v119
v_pk_mul_f32 v[112:113], v[112:113], v[48:49]
v_pk_mul_f32 v[114:115], v[114:115], v[50:51]
v_pk_mul_f32 v[116:117], v[116:117], v[80:81]
v_pk_mul_f32 v[118:119], v[118:119], v[82:83]
v_cvt_pk_bf16_f32 v120, v112, v113
v_cvt_pk_bf16_f32 v121, v114, v115
v_cvt_pk_bf16_f32 v122, v116, v117
v_cvt_pk_bf16_f32 v123, v118, v119
ds_write_b64 v28, v[120:121] offset:1024
ds_write_b64 v28, v[122:123] offset:1152
v_pk_fma_f32 v[52:53], v[52:53], v[8:9], v[248:249]
v_pk_fma_f32 v[54:55], v[54:55], v[10:11], v[250:251]
v_pk_fma_f32 v[84:85], v[84:85], v[8:9], v[248:249]
v_pk_fma_f32 v[86:87], v[86:87], v[10:11], v[250:251]
v_pk_mul_f32 v[112:113], v[52:53], v[52:53]
v_pk_mul_f32 v[114:115], v[54:55], v[54:55]
v_pk_mul_f32 v[116:117], v[84:85], v[84:85]
v_pk_mul_f32 v[118:119], v[86:87], v[86:87]
s_waitcnt lgkmcnt(0)
s_add_u32 s62, s75, 0
buffer_store_dwordx4 v[128:131], v27, s[28:31], s62 offen
s_add_u32 s62, s75, 8192
buffer_store_dwordx4 v[136:139], v27, s[28:31], s62 offen
s_add_u32 s62, s75, 16384
buffer_store_dwordx4 v[144:147], v27, s[28:31], s62 offen
s_add_u32 s62, s75, 24576
buffer_store_dwordx4 v[152:155], v27, s[28:31], s62 offen
v_pk_fma_f32 v[112:113], v[112:113], s[72:73], v[30:31]
v_pk_fma_f32 v[114:115], v[114:115], s[72:73], v[30:31]
v_pk_fma_f32 v[116:117], v[116:117], s[72:73], v[30:31]
v_pk_fma_f32 v[118:119], v[118:119], s[72:73], v[30:31]
v_pk_mul_f32 v[112:113], v[112:113], v[52:53]
v_pk_mul_f32 v[114:115], v[114:115], v[54:55]
v_pk_mul_f32 v[116:117], v[116:117], v[84:85]
v_pk_mul_f32 v[118:119], v[118:119], v[86:87]
v_exp_f32 v112, v112
v_exp_f32 v113, v113
v_exp_f32 v114, v114
v_exp_f32 v115, v115
v_exp_f32 v116, v116
v_exp_f32 v117, v117
v_exp_f32 v118, v118
v_exp_f32 v119, v119
v_pk_add_f32 v[112:113], v[112:113], v[22:23]
v_pk_add_f32 v[114:115], v[114:115], v[22:23]
v_pk_add_f32 v[116:117], v[116:117], v[22:23]
v_pk_add_f32 v[118:119], v[118:119], v[22:23]
v_rcp_f32 v112, v112
v_rcp_f32 v113, v113
v_rcp_f32 v114, v114
v_rcp_f32 v115, v115
v_rcp_f32 v116, v116
v_rcp_f32 v117, v117
v_rcp_f32 v118, v118
v_rcp_f32 v119, v119
v_pk_mul_f32 v[112:113], v[112:113], v[52:53]
v_pk_mul_f32 v[114:115], v[114:115], v[54:55]
v_pk_mul_f32 v[116:117], v[116:117], v[84:85]
v_pk_mul_f32 v[118:119], v[118:119], v[86:87]
v_cvt_pk_bf16_f32 v124, v112, v113
v_cvt_pk_bf16_f32 v125, v114, v115
v_cvt_pk_bf16_f32 v126, v116, v117
v_cvt_pk_bf16_f32 v127, v118, v119
ds_write_b64 v28, v[124:125] offset:1280
ds_write_b64 v28, v[126:127] offset:1408
v_pk_fma_f32 v[56:57], v[56:57], v[8:9], v[248:249]
v_pk_fma_f32 v[58:59], v[58:59], v[10:11], v[250:251]
v_pk_fma_f32 v[88:89], v[88:89], v[8:9], v[248:249]
v_pk_fma_f32 v[90:91], v[90:91], v[10:11], v[250:251]
v_pk_mul_f32 v[112:113], v[56:57], v[56:57]
v_pk_mul_f32 v[114:115], v[58:59], v[58:59]
v_pk_mul_f32 v[116:117], v[88:89], v[88:89]
v_pk_mul_f32 v[118:119], v[90:91], v[90:91]
v_pk_fma_f32 v[112:113], v[112:113], s[72:73], v[30:31]
v_pk_fma_f32 v[114:115], v[114:115], s[72:73], v[30:31]
v_pk_fma_f32 v[116:117], v[116:117], s[72:73], v[30:31]
v_pk_fma_f32 v[118:119], v[118:119], s[72:73], v[30:31]
v_pk_mul_f32 v[112:113], v[112:113], v[56:57]
v_pk_mul_f32 v[114:115], v[114:115], v[58:59]
v_pk_mul_f32 v[116:117], v[116:117], v[88:89]
v_pk_mul_f32 v[118:119], v[118:119], v[90:91]
v_exp_f32 v112, v112
v_exp_f32 v113, v113
v_exp_f32 v114, v114
v_exp_f32 v115, v115
v_exp_f32 v116, v116
v_exp_f32 v117, v117
v_exp_f32 v118, v118
v_exp_f32 v119, v119
v_pk_add_f32 v[112:113], v[112:113], v[22:23]
v_pk_add_f32 v[114:115], v[114:115], v[22:23]
v_pk_add_f32 v[116:117], v[116:117], v[22:23]
v_pk_add_f32 v[118:119], v[118:119], v[22:23]
v_rcp_f32 v112, v112
v_rcp_f32 v113, v113
v_rcp_f32 v114, v114
v_rcp_f32 v115, v115
v_rcp_f32 v116, v116
v_rcp_f32 v117, v117
v_rcp_f32 v118, v118
v_rcp_f32 v119, v119
v_pk_mul_f32 v[112:113], v[112:113], v[56:57]
v_pk_mul_f32 v[114:115], v[114:115], v[58:59]
v_pk_mul_f32 v[116:117], v[116:117], v[88:89]
v_pk_mul_f32 v[118:119], v[118:119], v[90:91]
v_cvt_pk_bf16_f32 v120, v112, v113
v_cvt_pk_bf16_f32 v121, v114, v115
v_cvt_pk_bf16_f32 v122, v116, v117
v_cvt_pk_bf16_f32 v123, v118, v119
ds_write_b64 v28, v[120:121] offset:1536
ds_write_b64 v28, v[122:123] offset:1664
v_pk_fma_f32 v[60:61], v[60:61], v[8:9], v[248:249]
v_pk_fma_f32 v[62:63], v[62:63], v[10:11], v[250:251]
v_pk_fma_f32 v[92:93], v[92:93], v[8:9], v[248:249]
v_pk_fma_f32 v[94:95], v[94:95], v[10:11], v[250:251]
v_pk_mul_f32 v[112:113], v[60:61], v[60:61]
v_pk_mul_f32 v[114:115], v[62:63], v[62:63]
v_pk_mul_f32 v[116:117], v[92:93], v[92:93]
v_pk_mul_f32 v[118:119], v[94:95], v[94:95]
v_pk_fma_f32 v[112:113], v[112:113], s[72:73], v[30:31]
v_pk_fma_f32 v[114:115], v[114:115], s[72:73], v[30:31]
v_pk_fma_f32 v[116:117], v[116:117], s[72:73], v[30:31]
v_pk_fma_f32 v[118:119], v[118:119], s[72:73], v[30:31]
v_pk_mul_f32 v[112:113], v[112:113], v[60:61]
v_pk_mul_f32 v[114:115], v[114:115], v[62:63]
v_pk_mul_f32 v[116:117], v[116:117], v[92:93]
v_pk_mul_f32 v[118:119], v[118:119], v[94:95]
v_exp_f32 v112, v112
v_exp_f32 v113, v113
v_exp_f32 v114, v114
v_exp_f32 v115, v115
v_exp_f32 v116, v116
v_exp_f32 v117, v117
v_exp_f32 v118, v118
v_exp_f32 v119, v119
v_pk_add_f32 v[112:113], v[112:113], v[22:23]
v_pk_add_f32 v[114:115], v[114:115], v[22:23]
v_pk_add_f32 v[116:117], v[116:117], v[22:23]
v_pk_add_f32 v[118:119], v[118:119], v[22:23]
v_rcp_f32 v112, v112
v_rcp_f32 v113, v113
v_rcp_f32 v114, v114
v_rcp_f32 v115, v115
v_rcp_f32 v116, v116
v_rcp_f32 v117, v117
v_rcp_f32 v118, v118
v_rcp_f32 v119, v119
v_pk_mul_f32 v[112:113], v[112:113], v[60:61]
v_pk_mul_f32 v[114:115], v[114:115], v[62:63]
v_pk_mul_f32 v[116:117], v[116:117], v[92:93]
v_pk_mul_f32 v[118:119], v[118:119], v[94:95]
v_cvt_pk_bf16_f32 v124, v112, v113
v_cvt_pk_bf16_f32 v125, v114, v115
v_cvt_pk_bf16_f32 v126, v116, v117
v_cvt_pk_bf16_f32 v127, v118, v119
ds_write_b64 v28, v[124:125] offset:1792
ds_write_b64 v28, v[126:127] offset:1920
s_waitcnt lgkmcnt(0)
s_barrier
ds_read_b128 v[132:135], v25 offset:1024
ds_read_b128 v[140:143], v25 offset:3088
ds_read_b128 v[148:151], v25 offset:5152
ds_read_b128 v[156:159], v25 offset:7216
s_waitcnt lgkmcnt(3)
s_add_u32 s62, s75, 4096
buffer_store_dwordx4 v[132:135], v27, s[28:31], s62 offen
s_waitcnt lgkmcnt(2)
s_add_u32 s62, s75, 12288
buffer_store_dwordx4 v[140:143], v27, s[28:31], s62 offen
s_waitcnt lgkmcnt(1)
s_add_u32 s62, s75, 20480
buffer_store_dwordx4 v[148:151], v27, s[28:31], s62 offen
s_waitcnt lgkmcnt(0)
s_add_u32 s62, s75, 28672
s_mov_b64 exec, s[76:77]
buffer_store_dwordx4 v[156:159], v27, s[28:31], s62 offen
s_mov_b64 exec, -1
LM_done:
s_endpgm
.section .rodata,"a"
.p2align 6
.amdhsa_kernel standalone__self_sup_conv_stem_wavlm__speech_kernel
  .amdhsa_next_free_vgpr 392
  .amdhsa_next_free_sgpr 102
  .amdhsa_accum_offset 256
  .amdhsa_group_segment_fixed_size 0
  .amdhsa_kernarg_size 56
  .amdhsa_user_sgpr_count 2
  .amdhsa_user_sgpr_kernarg_segment_ptr 1
  .amdhsa_system_sgpr_workgroup_id_x 1
  .amdhsa_float_denorm_mode_32 3
.end_amdhsa_kernel
```
